```python
import torch

def _softmax(x, axis=-1):
    return torch.softmax(x, dim=axis)
def _gelu(x):
    return torch.nn.functional.gelu(x, approximate="tanh")
def _silu(x):
    return torch.nn.functional.silu(x)
def _sigmoid(x):
    return torch.sigmoid(x)
def _layernorm(x, axis=-1, eps=1e-5):
    m = x.mean(dim=axis, keepdim=True)
    v = x.var(dim=axis, keepdim=True, unbiased=False)
    return (x - m) / torch.sqrt(v + eps)
def _scatter_add(tgt, idx, src, axis=0):
    return tgt.clone().index_add_(axis, idx, src)
def _segment_sum(src, seg, n):
    out = torch.zeros((n,) + src.shape[1:], dtype=src.dtype)
    return out.index_add_(0, seg, src)
def _pad(x, pw):
    flat = tuple(v for pair in reversed(pw) for v in pair)
    return torch.nn.functional.pad(x, flat)

kernel_name = 'standalone__gqa_block_cached__near_ridge'

def setup_inputs():

    _w = (lambda a: (lambda t: t.to(torch.bfloat16) if t.is_floating_point() else t)(torch.as_tensor(a)))
    B, Sq, D = 8, 64, 512
    Hq, Hkv, Sk, Dh = 32, 8, 1024, 128
    assert Hq % Hkv == 0, (Hq, Hkv)
    return {
        "x": _w((lambda *s: torch.randn(*s, dtype=torch.bfloat16) * 0.8)(B, Sq, D)),
        "k_cache": _w((lambda *s: torch.randn(*s, dtype=torch.bfloat16) * 0.8)(B, Hkv, Sk, Dh)),
        "v_cache": _w((lambda *s: torch.randn(*s, dtype=torch.bfloat16) * 0.05)(B, Hkv, Sk, Dh)),
        "wq": _w((lambda *s: torch.randn(*s, dtype=torch.bfloat16) * 0.8)(D, Hq * Dh) * (D ** -0.5)),
        "wo": _w((lambda *s: torch.randn(*s, dtype=torch.bfloat16) * 0.05)(Hq * Dh, D) * ((Hq * Dh) ** -0.5)),
    }

def reference(x, k_cache, v_cache, wq, wo):
    B, Sq, D = x.shape
    Hq, Dh = 32, 128
    Hkv = k_cache.shape[1]
    rep = Hq // Hkv
    q = (lambda x, *d: x.permute(*d))((x @ wq).reshape(B, Sq, Hq, Dh), 0, 2, 1, 3)
    k = (lambda x, n, axis: torch.repeat_interleave(x, n, dim=axis))(k_cache, rep, axis=1)
    v = (lambda x, n, axis: torch.repeat_interleave(x, n, dim=axis))(v_cache, rep, axis=1)
    scores = torch.einsum("bhqd,bhkd->bhqk", q, k) * (Dh ** -0.5)
    p = _softmax(scores, axis=-1)
    o = torch.einsum("bhqk,bhkd->bhqd", p, v)
    return (lambda x, *d: x.permute(*d))(o, 0, 2, 1, 3).reshape(B, Sq, Hq * Dh) @ wo
```

```asm
; @launch grid=(256,1,1) block=(256,1,1) lds=163840
.amdgcn_target "amdgcn-amd-amdhsa--gfx950"
.text
.globl standalone__gqa_block_cached__near_ridge_kernel
.p2align 8
.type standalone__gqa_block_cached__near_ridge_kernel,@function
standalone__gqa_block_cached__near_ridge_kernel:
    s_cmp_ge_u32 s2, 256
    s_cbranch_scc1 L_end
    s_load_dwordx8 s[4:11], s[0:1], 0
    s_load_dwordx8 s[12:19], s[0:1], 32
    s_memrealtime s[74:75]
    v_lshrrev_b32 v64, 6, v0
    v_and_b32 v0, 63, v0
    v_readfirstlane_b32 s3, v64
    s_and_b32 s40, s2, 7
    s_lshr_b32 s41, s2, 5
    s_bfe_u32 s42, s2, 0x20003
    s_lshl_b32 s43, s40, 2
    s_add_u32 s43, s43, s42
    v_lshrrev_b32 v65, 4, v0
    v_and_b32 v66, 15, v0
    v_lshlrev_b32 v67, 1, v65
    v_xor_b32 v67, v66, v67
    v_lshlrev_b32 v67, 4, v67
    v_lshl_add_u32 v50, v65, 13, v67
    v_xor_b32 v70, 128, v50
    v_add_u32 v51, 31744, v50
    v_add_u32 v52, 63488, v70
    v_add_u32 v53, 95232, v70
    v_lshrrev_b32 v68, 3, v0
    v_and_b32 v69, 7, v0
    v_xor_b32 v70, v69, v65
    v_lshlrev_b32 v70, 4, v70
    v_lshl_add_u32 v48, v68, 10, v70
    v_xor_b32 v70, 64, v48
    v_add_u32 v49, 7168, v70
    s_add_u32 s44, s42, s41
    s_mul_i32 s45, s44, 86
    s_lshr_b32 s45, s45, 8
    s_mul_i32 s45, s45, 3
    s_sub_u32 s44, s44, s45
    s_mul_i32 s58, s44, 3
    s_lshl_b32 s46, s3, 11
    s_add_u32 s46, s46, 131072
    s_lshl_b32 s47, s3, 12
    s_add_u32 s47, s47, 16384
    s_lshl_b32 s49, s3, 15
    s_lshl_b32 s44, s41, 16
    s_lshl_b32 s45, s3, 14
    s_add_u32 s44, s44, s45
    s_lshl_b32 s48, s43, 8
    s_lshl_b32 s45, s3, 17
    s_add_u32 s48, s48, s45
    s_sub_u32 s22, 0x80000, s44
    s_mov_b32 s23, 0x20000
    s_sub_u32 s34, 0x400000, s48
    s_mov_b32 s35, 0x20000
    s_waitcnt lgkmcnt(0)
    s_add_u32 s20, s4, s44
    s_addc_u32 s21, s5, 0
    s_and_b32 s21, s21, 0xffff
    s_add_u32 s32, s10, s48
    s_addc_u32 s33, s11, 0
    s_and_b32 s33, s33, 0xffff
    s_lshl_b32 s59, s58, 7
    s_add_u32 m0, s46, 0
    s_lshl_b32 s57, s58, 19
    buffer_load_dwordx4 v48, s[20:23], s59 offen offset:0 lds
    buffer_load_dwordx4 v49, s[20:23], s59 offen offset:1024 lds
    s_add_u32 m0, s47, 0
    s_add_u32 s58, s58, 1
    buffer_load_dwordx4 v50, s[32:35], s57 offen offset:0 lds
    buffer_load_dwordx4 v51, s[32:35], s57 offen offset:1024 lds
    buffer_load_dwordx4 v52, s[32:35], s57 offen offset:2048 lds
    buffer_load_dwordx4 v53, s[32:35], s57 offen offset:3072 lds
    s_and_b32 s58, s58, 7
    v_xor_b32 v70, v66, v65
    v_lshlrev_b32 v70, 4, v70
    v_lshl_add_u32 v112, v65, 8, v70
    v_lshl_add_u32 v70, v66, 8, v70
    v_add_u32 v100, s49, v70
    v_xor_b32 v113, 64, v112
    v_xor_b32 v114, 128, v112
    v_xor_b32 v115, 192, v112
    v_xor_b32 v101, 64, v100
    v_xor_b32 v102, 128, v100
    v_xor_b32 v103, 192, v100
    v_add_u32 v116, 4096, v112
    v_add_u32 v117, 4096, v113
    v_add_u32 v118, 4096, v114
    v_add_u32 v119, 4096, v115
    v_lshl_add_u32 v120, v65, 8, v67
    v_xor_b32 v121, 128, v120
    v_add_u32 v122, 4096, v120
    v_add_u32 v123, 4096, v121
    v_lshlrev_b32 v70, 1, v65
    v_xor_b32 v70, v70, v69
    v_lshlrev_b32 v70, 4, v70
    v_lshl_add_u32 v1, v68, 10, v70
    s_mov_b32 s62, 0x75643120
    s_cmp_eq_u32 s42, 1
    s_cselect_b32 s62, 0x67542310, s62
    s_cmp_eq_u32 s42, 2
    s_cselect_b32 s62, 0x76534201, s62
    s_cmp_eq_u32 s42, 3
    s_cselect_b32 s62, 0x76453201, s62
    s_mov_b32 s63, 0
    s_lshl_b64 s[62:63], s[62:63], 13
    s_mov_b64 s[60:61], s[62:63]
    s_lshl_b32 s50, s41, 3
    s_add_u32 s50, s50, s40
    s_lshl_b32 s50, s50, 2
    s_add_u32 s50, s50, s3
    s_lshl_b32 s50, s50, 16
    s_mov_b32 s26, 0x10000
    s_mov_b32 s27, 0x20000
    s_mov_b32 s30, 0x10000
    s_mov_b32 s31, 0x20000
    s_add_u32 s24, s6, s50
    s_addc_u32 s25, s7, 0
    s_and_b32 s25, s25, 0xffff
    s_add_u32 s28, s8, s50
    s_addc_u32 s29, s9, 0
    s_and_b32 s29, s29, 0xffff
    s_mov_b32 s64, s18
    s_and_b32 s65, s19, 0xffff
    s_mov_b32 s66, 0x810000
    s_mov_b32 s67, 0x20000
    s_mov_b32 s68, s16
    s_and_b32 s69, s17, 0xffff
    s_mov_b32 s70, 0x100
    s_mov_b32 s71, 0x20000
    v_mov_b32 v99, 0
    s_lshl_b32 s72, s41, 5
    s_or_b32 s51, s43, s3
    s_cbranch_scc1 L_nolead
    s_or_b32 s74, s74, 1
    v_mov_b32 v98, s74
    s_mov_b64 exec, 1
    buffer_store_dword v98, v99, s[68:71], s72 offen sc1
    s_mov_b64 exec, -1
L_nolead:
    s_lshl_b32 s59, s58, 7
    s_add_u32 m0, s46, 8192
    s_lshl_b32 s57, s58, 19
    buffer_load_dwordx4 v48, s[20:23], s59 offen offset:0 lds
    buffer_load_dwordx4 v49, s[20:23], s59 offen offset:1024 lds
    s_add_u32 m0, s47, 32768
    s_add_u32 s58, s58, 1
    buffer_load_dwordx4 v50, s[32:35], s57 offen offset:0 lds
    buffer_load_dwordx4 v51, s[32:35], s57 offen offset:1024 lds
    buffer_load_dwordx4 v52, s[32:35], s57 offen offset:2048 lds
    buffer_load_dwordx4 v53, s[32:35], s57 offen offset:3072 lds
    s_and_b32 s58, s58, 7
    v_lshrrev_b32 v70, 1, v66
    v_xor_b32 v70, v70, v65
    v_lshlrev_b32 v70, 4, v70
    v_lshl_add_u32 v70, v66, 7, v70
    v_add_u32 v54, 131072, v70
    v_xor_b32 v55, 64, v54
    v_and_b32 v72, 3, v0
    v_lshlrev_b32 v72, 3, v72
    v_lshrrev_b32 v73, 2, v0
    s_lshl_b32 s52, s3, 1
    v_and_b32 v71, 7, v73
    v_xor_b32 v71, s52, v71
    v_lshl_add_u32 v71, v71, 5, v72
    v_lshl_add_u32 v70, v65, 2, v73
    v_lshl_add_u32 v70, v70, 8, v71
    v_add_u32 v56, 16384, v70
    v_xor_b32 v57, 32, v56
    v_add_u32 v58, 65536, v56
    v_add_u32 v59, 65536, v57
    v_lshl_add_u32 v70, v73, 8, v71
    v_add_u32 v104, s49, v70
    v_xor_b32 v105, 32, v104
    v_xor_b32 v106, 64, v104
    v_xor_b32 v107, 96, v104
    v_xor_b32 v108, 128, v104
    v_xor_b32 v109, 160, v104
    v_xor_b32 v110, 192, v104
    v_xor_b32 v111, 224, v104
    v_and_b32 v70, 3, v68
    v_xor_b32 v70, s3, v70
    v_lshl_add_u32 v70, v70, 5, v72
    v_lshl_add_u32 v70, v73, 7, v70
    v_add_u32 v8, s49, v70
    v_xor_b32 v9, 32, v8
    v_xor_b32 v10, 64, v8
    v_xor_b32 v11, 96, v8
    v_lshlrev_b32 v13, 4, v0
    v_add_u32 v15, 131072, v13
    v_lshlrev_b32 v96, 4, v66
    v_add_u32 v96, 147456, v96
    v_mov_b32 v76, 0xff800000
    v_mov_b32 v77, 0xff800000
    v_mov_b32 v78, 0xff800000
    v_mov_b32 v79, 0xff800000
    s_mov_b32 s76, 0
    s_lshl_b32 s51, s41, 5
    s_add_u32 s51, s51, s43
    s_lshl_b32 s51, s51, 2
    s_add_u32 s51, s51, s3
    s_lshl_b32 s51, s51, 3
    s_add_u32 s77, s51, 8388608
    s_andn2_b32 s51, s2, 6
    s_lshl_b32 s51, s51, 7
    s_lshl_b32 s52, s3, 5
    s_add_u32 s51, s51, s52
    s_add_u32 s86, s51, 8404992
    s_and_b32 s78, s40, 6
    s_lshl_b32 s78, s78, 2
    s_lshl_b32 s51, s3, 1
    s_add_u32 s78, s78, s51
    s_and_b32 s79, s43, 7
    s_lshl_b32 s51, s78, 17
    s_lshl_b32 s52, s79, 7
    s_add_u32 s51, s51, s52
    s_add_u32 s36, s12, s51
    s_addc_u32 s37, s13, 0
    s_and_b32 s37, s37, 0xffff
    s_sub_u32 s38, 0x400000, s51
    s_mov_b32 s39, 0x20000
    v_mov_b32 v60, 0
    v_mov_b32 v61, 0
    v_mov_b32 v62, 0
    v_mov_b32 v63, 0
    v_mov_b32 v14, 0x3e0293ee
    v_lshrrev_b32 v12, 1, v65
    v_lshl_add_u32 v12, v12, 4, v66
    v_lshlrev_b32 v12, 4, v12
    v_and_b32 v70, 1, v65
    v_lshl_add_u32 v12, v70, 3, v12
    s_lshl_b32 s51, s3, 10
    s_add_u32 s51, s51, 131072
    v_add_u32 v12, s51, v12
    v_mfma_f32_32x32x16_bf16 v[128:143], v[60:63], v[60:63], 0
    v_mfma_f32_32x32x16_bf16 v[144:159], v[60:63], v[60:63], 0
    v_mfma_f32_32x32x16_bf16 v[160:175], v[60:63], v[60:63], 0
    v_mfma_f32_32x32x16_bf16 v[176:191], v[60:63], v[60:63], 0
    v_mfma_f32_32x32x16_bf16 v[192:207], v[60:63], v[60:63], 0
    v_mfma_f32_32x32x16_bf16 v[208:223], v[60:63], v[60:63], 0
    v_mfma_f32_32x32x16_bf16 v[224:239], v[60:63], v[60:63], 0
    v_mfma_f32_32x32x16_bf16 v[240:255], v[60:63], v[60:63], 0
    s_lshl_b32 s59, s58, 7
    s_add_u32 m0, s46, 16384
    s_lshl_b32 s57, s58, 19
    buffer_load_dwordx4 v48, s[20:23], s59 offen offset:0 lds
    buffer_load_dwordx4 v49, s[20:23], s59 offen offset:1024 lds
    s_add_u32 m0, s47, 65536
    s_add_u32 s58, s58, 1
    buffer_load_dwordx4 v50, s[32:35], s57 offen offset:0 lds
    buffer_load_dwordx4 v51, s[32:35], s57 offen offset:1024 lds
    buffer_load_dwordx4 v52, s[32:35], s57 offen offset:2048 lds
    buffer_load_dwordx4 v53, s[32:35], s57 offen offset:3072 lds
    s_and_b32 s58, s58, 7
    s_waitcnt vmcnt(12)
    s_barrier
    ds_read_b64_tr_b16 a[0:1], v56 offset:0
    ds_read_b64_tr_b16 a[2:3], v56 offset:1024
    ds_read_b64_tr_b16 a[4:5], v57 offset:0
    ds_read_b64_tr_b16 a[6:7], v57 offset:1024
    ds_read_b128 a[8:11], v54 offset:0
    ds_read_b128 a[12:15], v54 offset:2048
    ds_read_b128 a[16:19], v54 offset:4096
    ds_read_b128 a[20:23], v54 offset:6144
    ds_read_b64_tr_b16 a[24:25], v56 offset:8192
    ds_read_b64_tr_b16 a[26:27], v56 offset:9216
    ds_read_b64_tr_b16 a[28:29], v57 offset:8192
    ds_read_b64_tr_b16 a[30:31], v57 offset:9216
    ds_read_b128 a[32:35], v55 offset:0
    ds_read_b128 a[36:39], v55 offset:2048
    ds_read_b128 a[40:43], v55 offset:4096
    ds_read_b128 a[44:47], v55 offset:6144
    s_lshl_b32 s59, s58, 7
    s_add_u32 m0, s46, 24576
    s_lshl_b32 s57, s58, 19
    buffer_load_dwordx4 v48, s[20:23], s59 offen offset:0 lds
    buffer_load_dwordx4 v49, s[20:23], s59 offen offset:1024 lds
    s_add_u32 m0, s47, 98304
    s_add_u32 s58, s58, 1
    buffer_load_dwordx4 v50, s[32:35], s57 offen offset:0 lds
    buffer_load_dwordx4 v51, s[32:35], s57 offen offset:1024 lds
    buffer_load_dwordx4 v52, s[32:35], s57 offen offset:2048 lds
    buffer_load_dwordx4 v53, s[32:35], s57 offen offset:3072 lds
    s_and_b32 s58, s58, 7
    s_waitcnt lgkmcnt(0)
    s_waitcnt vmcnt(12)
    s_barrier
    ds_read_b64_tr_b16 a[48:49], v56 offset:32768
    ds_read_b64_tr_b16 a[50:51], v56 offset:33792
    ds_read_b64_tr_b16 a[52:53], v57 offset:32768
    ds_read_b64_tr_b16 a[54:55], v57 offset:33792
    v_mfma_f32_16x16x32_bf16 v[16:19], a[0:3], a[8:11], 0
    ds_read_b128 a[56:59], v54 offset:8192
    ds_read_b128 a[60:63], v54 offset:10240
    v_mfma_f32_16x16x32_bf16 v[20:23], a[4:7], a[8:11], 0
    ds_read_b128 a[64:67], v54 offset:12288
    s_lshl_b32 s59, s58, 7
    s_add_u32 m0, s46, 0
    v_mfma_f32_16x16x32_bf16 v[24:27], a[0:3], a[12:15], 0
    ds_read_b128 a[68:71], v54 offset:14336
    ds_read_b64_tr_b16 a[72:73], v56 offset:40960
    v_mfma_f32_16x16x32_bf16 v[28:31], a[4:7], a[12:15], 0
    ds_read_b64_tr_b16 a[74:75], v56 offset:41984
    s_lshl_b32 s57, s58, 19
    buffer_load_dwordx4 v48, s[20:23], s59 offen offset:0 lds
    v_mfma_f32_16x16x32_bf16 v[32:35], a[0:3], a[16:19], 0
    ds_read_b64_tr_b16 a[76:77], v57 offset:40960
    ds_read_b64_tr_b16 a[78:79], v57 offset:41984
    v_mfma_f32_16x16x32_bf16 v[36:39], a[4:7], a[16:19], 0
    ds_read_b128 a[80:83], v55 offset:8192
    buffer_load_dwordx4 v49, s[20:23], s59 offen offset:1024 lds
    s_add_u32 m0, s47, 0
    v_mfma_f32_16x16x32_bf16 v[40:43], a[0:3], a[20:23], 0
    ds_read_b128 a[84:87], v55 offset:10240
    ds_read_b128 a[88:91], v55 offset:12288
    v_mfma_f32_16x16x32_bf16 v[44:47], a[4:7], a[20:23], 0
    ds_read_b128 a[92:95], v55 offset:14336
    s_add_u32 s58, s58, 1
    v_mfma_f32_16x16x32_bf16 v[16:19], a[24:27], a[32:35], v[16:19]
    buffer_load_dwordx4 v50, s[32:35], s57 offen offset:0 lds
    buffer_load_dwordx4 v51, s[32:35], s57 offen offset:1024 lds
    v_mfma_f32_16x16x32_bf16 v[20:23], a[28:31], a[32:35], v[20:23]
    v_mfma_f32_16x16x32_bf16 v[24:27], a[24:27], a[36:39], v[24:27]
    buffer_load_dwordx4 v52, s[32:35], s57 offen offset:2048 lds
    buffer_load_dwordx4 v53, s[32:35], s57 offen offset:3072 lds
    v_mfma_f32_16x16x32_bf16 v[28:31], a[28:31], a[36:39], v[28:31]
    v_mfma_f32_16x16x32_bf16 v[32:35], a[24:27], a[40:43], v[32:35]
    s_and_b32 s58, s58, 7
    v_mfma_f32_16x16x32_bf16 v[36:39], a[28:31], a[40:43], v[36:39]
    v_mfma_f32_16x16x32_bf16 v[40:43], a[24:27], a[44:47], v[40:43]
    v_mfma_f32_16x16x32_bf16 v[44:47], a[28:31], a[44:47], v[44:47]
    s_waitcnt lgkmcnt(0)
    s_waitcnt vmcnt(12)
    s_barrier
    ds_read_b64_tr_b16 a[0:1], v58 offset:0
    ds_read_b64_tr_b16 a[2:3], v58 offset:1024
    ds_read_b64_tr_b16 a[4:5], v59 offset:0
    ds_read_b64_tr_b16 a[6:7], v59 offset:1024
    v_mfma_f32_16x16x32_bf16 v[16:19], a[48:51], a[56:59], v[16:19]
    ds_read_b128 a[8:11], v54 offset:16384
    ds_read_b128 a[12:15], v54 offset:18432
    v_mfma_f32_16x16x32_bf16 v[20:23], a[52:55], a[56:59], v[20:23]
    ds_read_b128 a[16:19], v54 offset:20480
    s_lshl_b32 s59, s58, 7
    s_add_u32 m0, s46, 8192
    v_mfma_f32_16x16x32_bf16 v[24:27], a[48:51], a[60:63], v[24:27]
    ds_read_b128 a[20:23], v54 offset:22528
    ds_read_b64_tr_b16 a[24:25], v58 offset:8192
    v_mfma_f32_16x16x32_bf16 v[28:31], a[52:55], a[60:63], v[28:31]
    ds_read_b64_tr_b16 a[26:27], v58 offset:9216
    s_lshl_b32 s57, s58, 19
    buffer_load_dwordx4 v48, s[20:23], s59 offen offset:0 lds
    v_mfma_f32_16x16x32_bf16 v[32:35], a[48:51], a[64:67], v[32:35]
    ds_read_b64_tr_b16 a[28:29], v59 offset:8192
    ds_read_b64_tr_b16 a[30:31], v59 offset:9216
    v_mfma_f32_16x16x32_bf16 v[36:39], a[52:55], a[64:67], v[36:39]
    ds_read_b128 a[32:35], v55 offset:16384
    buffer_load_dwordx4 v49, s[20:23], s59 offen offset:1024 lds
    s_add_u32 m0, s47, 32768
    v_mfma_f32_16x16x32_bf16 v[40:43], a[48:51], a[68:71], v[40:43]
    ds_read_b128 a[36:39], v55 offset:18432
    ds_read_b128 a[40:43], v55 offset:20480
    v_mfma_f32_16x16x32_bf16 v[44:47], a[52:55], a[68:71], v[44:47]
    ds_read_b128 a[44:47], v55 offset:22528
    s_add_u32 s58, s58, 1
    v_mfma_f32_16x16x32_bf16 v[16:19], a[72:75], a[80:83], v[16:19]
    buffer_load_dwordx4 v50, s[32:35], s57 offen offset:0 lds
    buffer_load_dwordx4 v51, s[32:35], s57 offen offset:1024 lds
    v_mfma_f32_16x16x32_bf16 v[20:23], a[76:79], a[80:83], v[20:23]
    v_mfma_f32_16x16x32_bf16 v[24:27], a[72:75], a[84:87], v[24:27]
    buffer_load_dwordx4 v52, s[32:35], s57 offen offset:2048 lds
    buffer_load_dwordx4 v53, s[32:35], s57 offen offset:3072 lds
    v_mfma_f32_16x16x32_bf16 v[28:31], a[76:79], a[84:87], v[28:31]
    v_mfma_f32_16x16x32_bf16 v[32:35], a[72:75], a[88:91], v[32:35]
    s_and_b32 s58, s58, 7
    v_mfma_f32_16x16x32_bf16 v[36:39], a[76:79], a[88:91], v[36:39]
    v_mfma_f32_16x16x32_bf16 v[40:43], a[72:75], a[92:95], v[40:43]
    v_mfma_f32_16x16x32_bf16 v[44:47], a[76:79], a[92:95], v[44:47]
    s_waitcnt lgkmcnt(0)
    s_waitcnt vmcnt(12)
    s_barrier
    ds_read_b64_tr_b16 a[48:49], v58 offset:32768
    ds_read_b64_tr_b16 a[50:51], v58 offset:33792
    ds_read_b64_tr_b16 a[52:53], v59 offset:32768
    ds_read_b64_tr_b16 a[54:55], v59 offset:33792
    v_mfma_f32_16x16x32_bf16 v[16:19], a[0:3], a[8:11], v[16:19]
    ds_read_b128 a[56:59], v54 offset:24576
    ds_read_b128 a[60:63], v54 offset:26624
    v_mfma_f32_16x16x32_bf16 v[20:23], a[4:7], a[8:11], v[20:23]
    ds_read_b128 a[64:67], v54 offset:28672
    s_lshl_b32 s59, s58, 7
    s_add_u32 m0, s46, 16384
    v_mfma_f32_16x16x32_bf16 v[24:27], a[0:3], a[12:15], v[24:27]
    ds_read_b128 a[68:71], v54 offset:30720
    ds_read_b64_tr_b16 a[72:73], v58 offset:40960
    v_mfma_f32_16x16x32_bf16 v[28:31], a[4:7], a[12:15], v[28:31]
    ds_read_b64_tr_b16 a[74:75], v58 offset:41984
    s_lshl_b32 s57, s58, 19
    buffer_load_dwordx4 v48, s[20:23], s59 offen offset:0 lds
    v_mfma_f32_16x16x32_bf16 v[32:35], a[0:3], a[16:19], v[32:35]
    ds_read_b64_tr_b16 a[76:77], v59 offset:40960
    ds_read_b64_tr_b16 a[78:79], v59 offset:41984
    v_mfma_f32_16x16x32_bf16 v[36:39], a[4:7], a[16:19], v[36:39]
    ds_read_b128 a[80:83], v55 offset:24576
    buffer_load_dwordx4 v49, s[20:23], s59 offen offset:1024 lds
    s_add_u32 m0, s47, 65536
    v_mfma_f32_16x16x32_bf16 v[40:43], a[0:3], a[20:23], v[40:43]
    ds_read_b128 a[84:87], v55 offset:26624
    ds_read_b128 a[88:91], v55 offset:28672
    v_mfma_f32_16x16x32_bf16 v[44:47], a[4:7], a[20:23], v[44:47]
    ds_read_b128 a[92:95], v55 offset:30720
    s_add_u32 s58, s58, 1
    v_mfma_f32_16x16x32_bf16 v[16:19], a[24:27], a[32:35], v[16:19]
    buffer_load_dwordx4 v50, s[32:35], s57 offen offset:0 lds
    buffer_load_dwordx4 v51, s[32:35], s57 offen offset:1024 lds
    v_mfma_f32_16x16x32_bf16 v[20:23], a[28:31], a[32:35], v[20:23]
    v_mfma_f32_16x16x32_bf16 v[24:27], a[24:27], a[36:39], v[24:27]
    buffer_load_dwordx4 v52, s[32:35], s57 offen offset:2048 lds
    buffer_load_dwordx4 v53, s[32:35], s57 offen offset:3072 lds
    v_mfma_f32_16x16x32_bf16 v[28:31], a[28:31], a[36:39], v[28:31]
    v_mfma_f32_16x16x32_bf16 v[32:35], a[24:27], a[40:43], v[32:35]
    s_and_b32 s58, s58, 7
    v_mfma_f32_16x16x32_bf16 v[36:39], a[28:31], a[40:43], v[36:39]
    v_mfma_f32_16x16x32_bf16 v[40:43], a[24:27], a[44:47], v[40:43]
    v_mfma_f32_16x16x32_bf16 v[44:47], a[28:31], a[44:47], v[44:47]
    v_lshrrev_b32 v70, 2, v66
    v_xor_b32 v70, v70, v65
    v_bfe_u32 v71, v0, 1, 1
    v_lshl_add_u32 v70, v70, 1, v71
    v_and_b32 v71, 1, v0
    v_lshlrev_b32 v71, 4, v71
    v_mov_b32 v4, 0x3f80
    v_lshlrev_b32 v71, v71, v4
    v_cmp_eq_u32 s[80:81], 0, v70
    v_cmp_eq_u32 s[82:83], 1, v70
    v_cmp_eq_u32 s[84:85], 0, v66
    v_mov_b32 v4, 0
    v_mov_b32 v5, 0
    v_mov_b32 v70, 0x3f803f80
    v_cndmask_b32 v2, 0, v71, s[80:81]
    v_cndmask_b32 v3, 0, v71, s[82:83]
    v_cndmask_b32 v70, 0, v70, s[84:85]
    v_mov_b32 v6, v2
    v_mov_b32 v7, v3
    v_accvgpr_write_b32 a116, v70
    v_accvgpr_write_b32 a117, v70
    v_accvgpr_write_b32 a118, v70
    v_accvgpr_write_b32 a119, v70
    s_mul_i32 s51, s41, 86
    s_lshr_b32 s51, s51, 8
    s_mul_i32 s51, s51, 3
    s_sub_u32 s80, s41, s51
    s_mul_i32 s80, s80, 3
    s_lshl_b32 s87, s3, 12
    s_add_u32 s87, s87, 131072
    s_sub_u32 s88, s87, s49
    s_lshl_b32 s51, s41, 9
    s_lshl_b32 s52, s43, 3
    s_add_u32 s51, s51, s52
    s_lshl_b32 s52, s3, 1
    s_add_u32 s51, s51, s52
    s_lshl_b32 s4, s51, 10
    s_add_u32 s5, s4, 262144
    s_mov_b32 s53, 0x53800000
    s_lshl_b32 s51, s41, 5
    s_add_u32 s51, s51, s78
    s_lshl_b32 s51, s51, 5
    s_add_u32 s55, s51, 8388608
    s_lshl_b32 s51, s41, 9
    s_lshl_b32 s52, s78, 3
    s_add_u32 s51, s51, s52
    s_lshl_b32 s51, s51, 10
    s_add_u32 s8, s18, s51
    s_addc_u32 s9, s19, 0
    s_and_b32 s9, s9, 0xffff
    s_mov_b32 s10, 0x44000
    s_mov_b32 s11, 0x20000
    s_xor_b32 s51, s2, 2
    s_mul_i32 s51, s51, 12288
    s_add_u32 s94, s51, 4194304
    s_xor_b32 s51, s2, 4
    s_mul_i32 s51, s51, 12288
    s_add_u32 s95, s51, 4198400
    s_xor_b32 s51, s2, 6
    s_mul_i32 s51, s51, 12288
    s_add_u32 s96, s51, 4202496
    s_mul_i32 s51, s2, 12288
    s_add_u32 s97, s51, 4194304
    s_add_u32 s98, s97, 4096
    s_add_u32 s99, s97, 8192
    s_mov_b32 s12, s14
    s_and_b32 s13, s15, 0xffff
    s_mov_b32 s14, 0x80000
    s_mov_b32 s15, 0x20000
    s_lshl_b32 s50, s41, 16
    s_and_b32 s51, s40, 6
    s_lshl_b32 s51, s51, 13
    s_add_u32 s50, s50, s51
    s_lshl_b32 s51, s79, 7
    s_add_u32 s50, s50, s51
    s_lshl_b32 s51, s3, 5
    s_add_u32 s50, s50, s51
    s_and_b32 s52, s2, 6
    s_lshl_b32 s74, s52, 1
    s_add_u32 s75, s86, s74
    s_and_b32 s52, s40, 4
    s_lshl_b32 s52, s52, 16
    s_and_b32 s51, s40, 2
    s_lshl_b32 s51, s51, 9
    s_or_b32 s16, s52, s51
    s_lshl_b32 s17, s3, 10
    s_waitcnt lgkmcnt(0)
    s_waitcnt vmcnt(12)
    s_barrier
    ds_read_b64_tr_b16 a[0:1], v56 offset:0
    ds_read_b64_tr_b16 a[2:3], v56 offset:1024
    ds_read_b64_tr_b16 a[4:5], v57 offset:0
    ds_read_b64_tr_b16 a[6:7], v57 offset:1024
    v_mfma_f32_16x16x32_bf16 v[16:19], a[48:51], a[56:59], v[16:19]
    ds_read_b128 a[8:11], v54 offset:0
    ds_read_b128 a[12:15], v54 offset:2048
    v_mfma_f32_16x16x32_bf16 v[20:23], a[52:55], a[56:59], v[20:23]
    ds_read_b128 a[16:19], v54 offset:4096
    s_lshl_b32 s59, s58, 7
    s_add_u32 m0, s46, 24576
    v_mfma_f32_16x16x32_bf16 v[24:27], a[48:51], a[60:63], v[24:27]
    ds_read_b128 a[20:23], v54 offset:6144
    ds_read_b64_tr_b16 a[24:25], v56 offset:8192
    v_mfma_f32_16x16x32_bf16 v[28:31], a[52:55], a[60:63], v[28:31]
    ds_read_b64_tr_b16 a[26:27], v56 offset:9216
    s_lshl_b32 s57, s58, 19
    buffer_load_dwordx4 v48, s[20:23], s59 offen offset:0 lds
    v_mfma_f32_16x16x32_bf16 v[32:35], a[48:51], a[64:67], v[32:35]
    ds_read_b64_tr_b16 a[28:29], v57 offset:8192
    ds_read_b64_tr_b16 a[30:31], v57 offset:9216
    v_mfma_f32_16x16x32_bf16 v[36:39], a[52:55], a[64:67], v[36:39]
    ds_read_b128 a[32:35], v55 offset:0
    buffer_load_dwordx4 v49, s[20:23], s59 offen offset:1024 lds
    s_add_u32 m0, s47, 98304
    v_mfma_f32_16x16x32_bf16 v[40:43], a[48:51], a[68:71], v[40:43]
    ds_read_b128 a[36:39], v55 offset:2048
    ds_read_b128 a[40:43], v55 offset:4096
    v_mfma_f32_16x16x32_bf16 v[44:47], a[52:55], a[68:71], v[44:47]
    ds_read_b128 a[44:47], v55 offset:6144
    s_add_u32 s58, s58, 1
    v_mfma_f32_16x16x32_bf16 v[16:19], a[72:75], a[80:83], v[16:19]
    buffer_load_dwordx4 v50, s[32:35], s57 offen offset:0 lds
    buffer_load_dwordx4 v51, s[32:35], s57 offen offset:1024 lds
    v_mfma_f32_16x16x32_bf16 v[20:23], a[76:79], a[80:83], v[20:23]
    v_mfma_f32_16x16x32_bf16 v[24:27], a[72:75], a[84:87], v[24:27]
    buffer_load_dwordx4 v52, s[32:35], s57 offen offset:2048 lds
    buffer_load_dwordx4 v53, s[32:35], s57 offen offset:3072 lds
    v_mfma_f32_16x16x32_bf16 v[28:31], a[76:79], a[84:87], v[28:31]
    v_mfma_f32_16x16x32_bf16 v[32:35], a[72:75], a[88:91], v[32:35]
    s_and_b32 s58, s58, 7
    v_mfma_f32_16x16x32_bf16 v[36:39], a[76:79], a[88:91], v[36:39]
    v_mfma_f32_16x16x32_bf16 v[40:43], a[72:75], a[92:95], v[40:43]
    v_mfma_f32_16x16x32_bf16 v[44:47], a[76:79], a[92:95], v[44:47]
    s_waitcnt lgkmcnt(0)
    s_waitcnt vmcnt(12)
    s_barrier
    ds_read_b64_tr_b16 a[48:49], v56 offset:32768
    ds_read_b64_tr_b16 a[50:51], v56 offset:33792
    ds_read_b64_tr_b16 a[52:53], v57 offset:32768
    ds_read_b64_tr_b16 a[54:55], v57 offset:33792
    v_mfma_f32_16x16x32_bf16 v[16:19], a[0:3], a[8:11], v[16:19]
    ds_read_b128 a[56:59], v54 offset:8192
    ds_read_b128 a[60:63], v54 offset:10240
    v_mfma_f32_16x16x32_bf16 v[20:23], a[4:7], a[8:11], v[20:23]
    ds_read_b128 a[64:67], v54 offset:12288
    s_and_b32 s54, s60, 0x1e000
    v_mfma_f32_16x16x32_bf16 v[24:27], a[0:3], a[12:15], v[24:27]
    ds_read_b128 a[68:71], v54 offset:14336
    ds_read_b64_tr_b16 a[72:73], v56 offset:40960
    v_mfma_f32_16x16x32_bf16 v[28:31], a[4:7], a[12:15], v[28:31]
    ds_read_b64_tr_b16 a[74:75], v56 offset:41984
    s_lshr_b64 s[60:61], s[60:61], 4
    v_mfma_f32_16x16x32_bf16 v[32:35], a[0:3], a[16:19], v[32:35]
    ds_read_b64_tr_b16 a[76:77], v57 offset:40960
    ds_read_b64_tr_b16 a[78:79], v57 offset:41984
    v_mfma_f32_16x16x32_bf16 v[36:39], a[4:7], a[16:19], v[36:39]
    ds_read_b128 a[80:83], v55 offset:8192
    s_add_u32 m0, s49, 0
    v_mfma_f32_16x16x32_bf16 v[40:43], a[0:3], a[20:23], v[40:43]
    ds_read_b128 a[84:87], v55 offset:10240
    ds_read_b128 a[88:91], v55 offset:12288
    v_mfma_f32_16x16x32_bf16 v[44:47], a[4:7], a[20:23], v[44:47]
    ds_read_b128 a[92:95], v55 offset:14336
    buffer_load_dwordx4 v112, s[24:27], s54 offen offset:0 lds
    v_mfma_f32_16x16x32_bf16 v[16:19], a[24:27], a[32:35], v[16:19]
    buffer_load_dwordx4 v113, s[24:27], s54 offen offset:1024 lds
    v_mfma_f32_16x16x32_bf16 v[20:23], a[28:31], a[32:35], v[20:23]
    v_mfma_f32_16x16x32_bf16 v[24:27], a[24:27], a[36:39], v[24:27]
    buffer_load_dwordx4 v114, s[24:27], s54 offen offset:2048 lds
    v_mfma_f32_16x16x32_bf16 v[28:31], a[28:31], a[36:39], v[28:31]
    v_mfma_f32_16x16x32_bf16 v[32:35], a[24:27], a[40:43], v[32:35]
    buffer_load_dwordx4 v115, s[24:27], s54 offen offset:3072 lds
    v_mfma_f32_16x16x32_bf16 v[36:39], a[28:31], a[40:43], v[36:39]
    v_mfma_f32_16x16x32_bf16 v[40:43], a[24:27], a[44:47], v[40:43]
    v_mfma_f32_16x16x32_bf16 v[44:47], a[28:31], a[44:47], v[44:47]
    s_waitcnt lgkmcnt(0)
    s_waitcnt vmcnt(10)
    s_barrier
    ds_read_b64_tr_b16 a[0:1], v58 offset:0
    ds_read_b64_tr_b16 a[2:3], v58 offset:1024
    ds_read_b64_tr_b16 a[4:5], v59 offset:0
    ds_read_b64_tr_b16 a[6:7], v59 offset:1024
    v_mfma_f32_16x16x32_bf16 v[16:19], a[48:51], a[56:59], v[16:19]
    ds_read_b128 a[8:11], v54 offset:16384
    ds_read_b128 a[12:15], v54 offset:18432
    v_mfma_f32_16x16x32_bf16 v[20:23], a[52:55], a[56:59], v[20:23]
    ds_read_b128 a[16:19], v54 offset:20480
    s_add_u32 m0, s49, 4096
    v_mfma_f32_16x16x32_bf16 v[24:27], a[48:51], a[60:63], v[24:27]
    ds_read_b128 a[20:23], v54 offset:22528
    ds_read_b64_tr_b16 a[24:25], v58 offset:8192
    v_mfma_f32_16x16x32_bf16 v[28:31], a[52:55], a[60:63], v[28:31]
    ds_read_b64_tr_b16 a[26:27], v58 offset:9216
    buffer_load_dwordx4 v116, s[24:27], s54 offen offset:0 lds
    v_mfma_f32_16x16x32_bf16 v[32:35], a[48:51], a[64:67], v[32:35]
    ds_read_b64_tr_b16 a[28:29], v59 offset:8192
    ds_read_b64_tr_b16 a[30:31], v59 offset:9216
    v_mfma_f32_16x16x32_bf16 v[36:39], a[52:55], a[64:67], v[36:39]
    ds_read_b128 a[32:35], v55 offset:16384
    buffer_load_dwordx4 v117, s[24:27], s54 offen offset:1024 lds
    v_mfma_f32_16x16x32_bf16 v[40:43], a[48:51], a[68:71], v[40:43]
    ds_read_b128 a[36:39], v55 offset:18432
    ds_read_b128 a[40:43], v55 offset:20480
    v_mfma_f32_16x16x32_bf16 v[44:47], a[52:55], a[68:71], v[44:47]
    ds_read_b128 a[44:47], v55 offset:22528
    v_mfma_f32_16x16x32_bf16 v[16:19], a[72:75], a[80:83], v[16:19]
    buffer_load_dwordx4 v118, s[24:27], s54 offen offset:2048 lds
    v_mfma_f32_16x16x32_bf16 v[20:23], a[76:79], a[80:83], v[20:23]
    v_mfma_f32_16x16x32_bf16 v[24:27], a[72:75], a[84:87], v[24:27]
    buffer_load_dwordx4 v119, s[24:27], s54 offen offset:3072 lds
    v_mfma_f32_16x16x32_bf16 v[28:31], a[76:79], a[84:87], v[28:31]
    v_mfma_f32_16x16x32_bf16 v[32:35], a[72:75], a[88:91], v[32:35]
    v_mfma_f32_16x16x32_bf16 v[36:39], a[76:79], a[88:91], v[36:39]
    v_mfma_f32_16x16x32_bf16 v[40:43], a[72:75], a[92:95], v[40:43]
    v_mfma_f32_16x16x32_bf16 v[44:47], a[76:79], a[92:95], v[44:47]
    s_waitcnt lgkmcnt(0)
    s_waitcnt vmcnt(8)
    s_barrier
    ds_read_b64_tr_b16 a[48:49], v58 offset:32768
    ds_read_b64_tr_b16 a[50:51], v58 offset:33792
    ds_read_b64_tr_b16 a[52:53], v59 offset:32768
    ds_read_b64_tr_b16 a[54:55], v59 offset:33792
    v_mfma_f32_16x16x32_bf16 v[16:19], a[0:3], a[8:11], v[16:19]
    ds_read_b128 a[56:59], v54 offset:24576
    ds_read_b128 a[60:63], v54 offset:26624
    v_mfma_f32_16x16x32_bf16 v[20:23], a[4:7], a[8:11], v[20:23]
    ds_read_b128 a[64:67], v54 offset:28672
    s_add_u32 m0, s49, 8192
    v_mfma_f32_16x16x32_bf16 v[24:27], a[0:3], a[12:15], v[24:27]
    ds_read_b128 a[68:71], v54 offset:30720
    ds_read_b64_tr_b16 a[72:73], v58 offset:40960
    v_mfma_f32_16x16x32_bf16 v[28:31], a[4:7], a[12:15], v[28:31]
    ds_read_b64_tr_b16 a[74:75], v58 offset:41984
    buffer_load_dwordx4 v120, s[28:31], s54 offen offset:0 lds
    v_mfma_f32_16x16x32_bf16 v[32:35], a[0:3], a[16:19], v[32:35]
    ds_read_b64_tr_b16 a[76:77], v59 offset:40960
    ds_read_b64_tr_b16 a[78:79], v59 offset:41984
    v_mfma_f32_16x16x32_bf16 v[36:39], a[4:7], a[16:19], v[36:39]
    ds_read_b128 a[80:83], v55 offset:24576
    buffer_load_dwordx4 v121, s[28:31], s54 offen offset:1024 lds
    v_mfma_f32_16x16x32_bf16 v[40:43], a[0:3], a[20:23], v[40:43]
    ds_read_b128 a[84:87], v55 offset:26624
    ds_read_b128 a[88:91], v55 offset:28672
    v_mfma_f32_16x16x32_bf16 v[44:47], a[4:7], a[20:23], v[44:47]
    ds_read_b128 a[92:95], v55 offset:30720
    v_mfma_f32_16x16x32_bf16 v[16:19], a[24:27], a[32:35], v[16:19]
    buffer_load_dwordx4 v120, s[28:31], s54 offen offset:2048 lds
    v_mfma_f32_16x16x32_bf16 v[20:23], a[28:31], a[32:35], v[20:23]
    v_mfma_f32_16x16x32_bf16 v[24:27], a[24:27], a[36:39], v[24:27]
    buffer_load_dwordx4 v121, s[28:31], s54 offen offset:3072 lds
    v_mfma_f32_16x16x32_bf16 v[28:31], a[28:31], a[36:39], v[28:31]
    v_mfma_f32_16x16x32_bf16 v[32:35], a[24:27], a[40:43], v[32:35]
    v_mfma_f32_16x16x32_bf16 v[36:39], a[28:31], a[40:43], v[36:39]
    v_mfma_f32_16x16x32_bf16 v[40:43], a[24:27], a[44:47], v[40:43]
    v_mfma_f32_16x16x32_bf16 v[44:47], a[28:31], a[44:47], v[44:47]
    s_waitcnt lgkmcnt(0)
    v_mfma_f32_16x16x32_bf16 v[16:19], a[48:51], a[56:59], v[16:19]
    v_mfma_f32_16x16x32_bf16 v[20:23], a[52:55], a[56:59], v[20:23]
    v_mfma_f32_16x16x32_bf16 v[16:19], a[72:75], a[80:83], v[16:19]
    v_mfma_f32_16x16x32_bf16 v[20:23], a[76:79], a[80:83], v[20:23]
    v_mfma_f32_16x16x32_bf16 v[24:27], a[48:51], a[60:63], v[24:27]
    v_mfma_f32_16x16x32_bf16 v[28:31], a[52:55], a[60:63], v[28:31]
    v_mfma_f32_16x16x32_bf16 v[24:27], a[72:75], a[84:87], v[24:27]
    v_mul_f32 v16, v14, v16
    v_mul_f32 v17, v14, v17
    v_mfma_f32_16x16x32_bf16 v[28:31], a[76:79], a[84:87], v[28:31]
    v_mul_f32 v18, v14, v18
    v_mul_f32 v19, v14, v19
    v_mfma_f32_16x16x32_bf16 v[32:35], a[48:51], a[64:67], v[32:35]
    v_mul_f32 v20, v14, v20
    v_mul_f32 v21, v14, v21
    v_mfma_f32_16x16x32_bf16 v[36:39], a[52:55], a[64:67], v[36:39]
    v_mul_f32 v22, v14, v22
    v_mfma_f32_16x16x32_bf16 v[32:35], a[72:75], a[88:91], v[32:35]
    v_mul_f32 v23, v14, v23
    v_cvt_pk_bf16_f32 v80, v16, v17
    v_mfma_f32_16x16x32_bf16 v[36:39], a[76:79], a[88:91], v[36:39]
    v_cvt_pk_bf16_f32 v81, v18, v19
    v_mfma_f32_16x16x32_bf16 v[40:43], a[48:51], a[68:71], v[40:43]
    v_cvt_pk_bf16_f32 v82, v20, v21
    v_cvt_pk_bf16_f32 v83, v22, v23
    v_mfma_f32_16x16x32_bf16 v[44:47], a[52:55], a[68:71], v[44:47]
    ds_write_b64 v12, v[80:81] offset:0
    v_mfma_f32_16x16x32_bf16 v[40:43], a[72:75], a[92:95], v[40:43]
    ds_write_b64 v12, v[82:83] offset:512
    v_mul_f32 v24, v14, v24
    v_mfma_f32_16x16x32_bf16 v[44:47], a[76:79], a[92:95], v[44:47]
    v_mul_f32 v25, v14, v25
    v_mul_f32 v26, v14, v26
    v_mul_f32 v27, v14, v27
    v_mul_f32 v28, v14, v28
    v_mul_f32 v29, v14, v29
    v_mul_f32 v30, v14, v30
    v_mul_f32 v31, v14, v31
    v_cvt_pk_bf16_f32 v84, v24, v25
    v_cvt_pk_bf16_f32 v85, v26, v27
    v_cvt_pk_bf16_f32 v86, v28, v29
    v_cvt_pk_bf16_f32 v87, v30, v31
    ds_write_b64 v12, v[84:85] offset:4096
    ds_write_b64 v12, v[86:87] offset:4608
    v_pk_mul_f32 v[32:33], v[32:33], v[14:15] op_sel_hi:[1,0]
    v_pk_mul_f32 v[34:35], v[34:35], v[14:15] op_sel_hi:[1,0]
    v_pk_mul_f32 v[36:37], v[36:37], v[14:15] op_sel_hi:[1,0]
    v_pk_mul_f32 v[38:39], v[38:39], v[14:15] op_sel_hi:[1,0]
    v_cvt_pk_bf16_f32 v88, v32, v33
    v_cvt_pk_bf16_f32 v89, v34, v35
    v_cvt_pk_bf16_f32 v90, v36, v37
    v_cvt_pk_bf16_f32 v91, v38, v39
    ds_write_b64 v12, v[88:89] offset:8192
    ds_write_b64 v12, v[90:91] offset:8704
    v_pk_mul_f32 v[40:41], v[40:41], v[14:15] op_sel_hi:[1,0]
    v_pk_mul_f32 v[42:43], v[42:43], v[14:15] op_sel_hi:[1,0]
    v_pk_mul_f32 v[44:45], v[44:45], v[14:15] op_sel_hi:[1,0]
    v_pk_mul_f32 v[46:47], v[46:47], v[14:15] op_sel_hi:[1,0]
    v_cvt_pk_bf16_f32 v92, v40, v41
    v_cvt_pk_bf16_f32 v93, v42, v43
    v_cvt_pk_bf16_f32 v94, v44, v45
    v_cvt_pk_bf16_f32 v95, v46, v47
    ds_write_b64 v12, v[92:93] offset:12288
    ds_write_b64 v12, v[94:95] offset:12800
    s_add_u32 m0, s49, 12288
    s_nop 0
    buffer_load_dwordx4 v122, s[28:31], s54 offen offset:0 lds
    buffer_load_dwordx4 v123, s[28:31], s54 offen offset:1024 lds
    buffer_load_dwordx4 v122, s[28:31], s54 offen offset:2048 lds
    buffer_load_dwordx4 v123, s[28:31], s54 offen offset:3072 lds
    s_waitcnt lgkmcnt(0)
L_att:
    s_barrier
    ds_read_b128 a[128:131], v15 offset:0
    ds_read_b128 a[132:135], v15 offset:1024
    ds_read_b128 a[136:139], v15 offset:2048
    ds_read_b128 a[140:143], v15 offset:3072
    ds_read_b128 a[144:147], v15 offset:4096
    ds_read_b128 a[148:151], v15 offset:5120
    ds_read_b128 a[152:155], v15 offset:6144
    ds_read_b128 a[156:159], v15 offset:7168
    s_waitcnt vmcnt(8)
    ds_read_b128 a[192:195], v100 offset:0
    ds_read_b128 a[196:199], v100 offset:4096
    ds_read_b128 a[200:203], v101 offset:0
    ds_read_b128 a[204:207], v101 offset:4096
    ds_read_b128 a[208:211], v102 offset:0
    ds_read_b128 a[212:215], v102 offset:4096
    ds_read_b128 a[216:219], v103 offset:0
    ds_read_b128 a[220:223], v103 offset:4096
    s_and_b32 s54, s60, 0x1e000
    s_lshr_b64 s[60:61], s[60:61], 4
    s_add_u32 m0, s49, 16384
    s_nop 0
    buffer_load_dwordx4 v112, s[24:27], s54 offen offset:0 lds
    s_waitcnt lgkmcnt(4)
    v_mfma_f32_16x16x32_bf16 v[16:19], a[192:195], a[128:131], 0
    ds_read_b128 a[160:163], v15 offset:8192
    ds_read_b128 a[164:167], v15 offset:9216
    v_mfma_f32_16x16x32_bf16 v[20:23], a[196:199], a[128:131], 0
    buffer_load_dwordx4 v113, s[24:27], s54 offen offset:1024 lds
    v_mfma_f32_16x16x32_bf16 v[16:19], a[200:203], a[132:135], v[16:19]
    ds_read_b128 a[168:171], v15 offset:10240
    ds_read_b128 a[172:175], v15 offset:11264
    v_mfma_f32_16x16x32_bf16 v[20:23], a[204:207], a[132:135], v[20:23]
    buffer_load_dwordx4 v114, s[24:27], s54 offen offset:2048 lds
    s_waitcnt lgkmcnt(4)
    v_mfma_f32_16x16x32_bf16 v[16:19], a[208:211], a[136:139], v[16:19]
    ds_read_b128 a[176:179], v15 offset:12288
    ds_read_b128 a[180:183], v15 offset:13312
    v_mfma_f32_16x16x32_bf16 v[20:23], a[212:215], a[136:139], v[20:23]
    v_mfma_f32_16x16x32_bf16 v[16:19], a[216:219], a[140:143], v[16:19]
    ds_read_b128 a[184:187], v15 offset:14336
    ds_read_b128 a[188:191], v15 offset:15360
    v_mfma_f32_16x16x32_bf16 v[20:23], a[220:223], a[140:143], v[20:23]
    buffer_load_dwordx4 v115, s[24:27], s54 offen offset:3072 lds
    v_mfma_f32_16x16x32_bf16 v[24:27], a[192:195], a[144:147], 0
    v_accvgpr_write_b32 a96, 0
    v_accvgpr_write_b32 a100, 0
    v_mfma_f32_16x16x32_bf16 v[28:31], a[196:199], a[144:147], 0
    v_mfma_f32_16x16x32_bf16 v[24:27], a[200:203], a[148:151], v[24:27]
    s_add_u32 m0, s49, 20480
    v_accvgpr_write_b32 a104, 0
    v_mfma_f32_16x16x32_bf16 v[28:31], a[204:207], a[148:151], v[28:31]
    v_accvgpr_write_b32 a108, 0
    v_mfma_f32_16x16x32_bf16 v[24:27], a[208:211], a[152:155], v[24:27]
    v_max3_f32 v64, v16, v17, v18
    v_max3_f32 v64, v64, v19, v20
    v_mfma_f32_16x16x32_bf16 v[28:31], a[212:215], a[152:155], v[28:31]
    v_mfma_f32_16x16x32_bf16 v[24:27], a[216:219], a[156:159], v[24:27]
    buffer_load_dwordx4 v116, s[24:27], s54 offen offset:0 lds
    v_max3_f32 v64, v64, v21, v22
    v_mfma_f32_16x16x32_bf16 v[28:31], a[220:223], a[156:159], v[28:31]
    v_max_f32 v64, v64, v23
    s_waitcnt lgkmcnt(0)
    v_mfma_f32_16x16x32_bf16 v[32:35], a[192:195], a[160:163], 0
    buffer_load_dwordx4 v117, s[24:27], s54 offen offset:1024 lds
    s_lshl_b32 s51, s3, 2
    v_mfma_f32_16x16x32_bf16 v[36:39], a[196:199], a[160:163], 0
    s_add_u32 s51, s51, 147456
    v_mfma_f32_16x16x32_bf16 v[32:35], a[200:203], a[164:167], v[32:35]
    v_add_u32 v12, s51, v13
    v_mfma_f32_16x16x32_bf16 v[36:39], a[204:207], a[164:167], v[36:39]
    v_mfma_f32_16x16x32_bf16 v[32:35], a[208:211], a[168:171], v[32:35]
    buffer_load_dwordx4 v118, s[24:27], s54 offen offset:2048 lds
    v_max3_f32 v65, v24, v25, v26
    v_mfma_f32_16x16x32_bf16 v[36:39], a[212:215], a[168:171], v[36:39]
    v_max3_f32 v65, v65, v27, v28
    v_mfma_f32_16x16x32_bf16 v[32:35], a[216:219], a[172:175], v[32:35]
    v_max3_f32 v65, v65, v29, v30
    v_max_f32 v65, v65, v31
    v_mfma_f32_16x16x32_bf16 v[36:39], a[220:223], a[172:175], v[36:39]
    v_mfma_f32_16x16x32_bf16 v[40:43], a[192:195], a[176:179], 0
    buffer_load_dwordx4 v119, s[24:27], s54 offen offset:3072 lds
    v_mfma_f32_16x16x32_bf16 v[44:47], a[196:199], a[176:179], 0
    v_mfma_f32_16x16x32_bf16 v[40:43], a[200:203], a[180:183], v[40:43]
    v_mfma_f32_16x16x32_bf16 v[44:47], a[204:207], a[180:183], v[44:47]
    v_mfma_f32_16x16x32_bf16 v[40:43], a[208:211], a[184:187], v[40:43]
    v_max3_f32 v66, v32, v33, v34
    v_max3_f32 v66, v66, v35, v36
    v_mfma_f32_16x16x32_bf16 v[44:47], a[212:215], a[184:187], v[44:47]
    v_mfma_f32_16x16x32_bf16 v[40:43], a[216:219], a[188:191], v[40:43]
    v_max3_f32 v66, v66, v37, v38
    v_max_f32 v66, v66, v39
    v_mfma_f32_16x16x32_bf16 v[44:47], a[220:223], a[188:191], v[44:47]
    s_add_u32 m0, s49, 24576
    s_nop 0
    buffer_load_dwordx4 v120, s[28:31], s54 offen offset:0 lds
    s_nop 3
    v_max3_f32 v67, v40, v41, v42
    v_max3_f32 v67, v67, v43, v44
    v_max3_f32 v67, v67, v45, v46
    v_max_f32 v67, v67, v47
    s_nop 1
    v_permlane32_swap_b32 v64, v66
    v_permlane32_swap_b32 v65, v67
    s_nop 0
    v_max_f32 v64, v64, v66
    v_max_f32 v65, v65, v67
    s_nop 1
    v_permlane16_swap_b32 v64, v65
    s_nop 0
    v_max_f32 v64, v64, v65
    ds_write_b32 v12, v64
    buffer_load_dwordx4 v121, s[28:31], s54 offen offset:1024 lds
    s_waitcnt lgkmcnt(0)
    s_barrier
    ds_read_b128 v[48:51], v96 offset:0
    ds_read_b128 v[52:55], v96 offset:256
    ds_read_b128 v[56:59], v96 offset:512
    ds_read_b128 v[60:63], v96 offset:768
    s_waitcnt vmcnt(10)
    ds_read_b64_tr_b16 a[224:225], v104 offset:8192
    ds_read_b64_tr_b16 a[226:227], v104 offset:12288
    ds_read_b64_tr_b16 a[228:229], v105 offset:8192
    ds_read_b64_tr_b16 a[230:231], v105 offset:12288
    ds_read_b64_tr_b16 a[232:233], v106 offset:8192
    ds_read_b64_tr_b16 a[234:235], v106 offset:12288
    ds_read_b64_tr_b16 a[236:237], v107 offset:8192
    ds_read_b64_tr_b16 a[238:239], v107 offset:12288
    s_waitcnt lgkmcnt(8)
    v_max3_f32 v64, v48, v49, v76
    v_max3_f32 v65, v52, v53, v77
    v_max3_f32 v66, v56, v57, v78
    v_max3_f32 v67, v60, v61, v79
    v_max3_f32 v64, v50, v51, v64
    v_max3_f32 v65, v54, v55, v65
    v_max3_f32 v66, v58, v59, v66
    v_max3_f32 v67, v62, v63, v67
    v_sub_f32 v48, 0, v64
    v_sub_f32 v49, 0, v64
    v_sub_f32 v52, 0, v65
    v_sub_f32 v53, 0, v65
    v_sub_f32 v56, 0, v66
    v_sub_f32 v57, 0, v66
    v_sub_f32 v60, 0, v67
    v_sub_f32 v61, 0, v67
    v_pk_add_f32 v[16:17], v[16:17], v[48:49]
    buffer_load_dwordx4 v120, s[28:31], s54 offen offset:2048 lds
    v_pk_add_f32 v[18:19], v[18:19], v[48:49]
    v_pk_add_f32 v[20:21], v[20:21], v[48:49]
    v_pk_add_f32 v[22:23], v[22:23], v[48:49]
    v_pk_add_f32 v[24:25], v[24:25], v[52:53]
    ds_read_b64_tr_b16 a[240:241], v108 offset:8192
    v_pk_add_f32 v[26:27], v[26:27], v[52:53]
    v_pk_add_f32 v[28:29], v[28:29], v[52:53]
    v_pk_add_f32 v[30:31], v[30:31], v[52:53]
    buffer_load_dwordx4 v121, s[28:31], s54 offen offset:3072 lds
    ds_read_b64_tr_b16 a[242:243], v108 offset:12288
    v_exp_f32 v16, v16
    v_exp_f32 v17, v17
    v_exp_f32 v18, v18
    v_cvt_pk_bf16_f32 v80, v16, v17
    ds_read_b64_tr_b16 a[244:245], v109 offset:8192
    v_exp_f32 v19, v19
    v_exp_f32 v20, v20
    v_cvt_pk_bf16_f32 v81, v18, v19
    s_add_u32 m0, s49, 28672
    v_exp_f32 v21, v21
    ds_read_b64_tr_b16 a[246:247], v109 offset:12288
    v_exp_f32 v22, v22
    v_cvt_pk_bf16_f32 v82, v20, v21
    v_exp_f32 v23, v23
    ds_read_b64_tr_b16 a[248:249], v110 offset:8192
    v_exp_f32 v24, v24
    v_cvt_pk_bf16_f32 v83, v22, v23
    v_exp_f32 v25, v25
    buffer_load_dwordx4 v122, s[28:31], s54 offen offset:0 lds
    v_exp_f32 v26, v26
    ds_read_b64_tr_b16 a[250:251], v110 offset:12288
    v_cvt_pk_bf16_f32 v84, v24, v25
    v_exp_f32 v27, v27
    v_exp_f32 v28, v28
    v_cvt_pk_bf16_f32 v85, v26, v27
    ds_read_b64_tr_b16 a[252:253], v111 offset:8192
    v_exp_f32 v29, v29
    v_exp_f32 v30, v30
    buffer_load_dwordx4 v123, s[28:31], s54 offen offset:1024 lds
    v_cvt_pk_bf16_f32 v86, v28, v29
    v_exp_f32 v31, v31
    v_pk_add_f32 v[32:33], v[32:33], v[56:57]
    v_pk_add_f32 v[34:35], v[34:35], v[56:57]
    v_pk_add_f32 v[36:37], v[36:37], v[56:57]
    v_pk_add_f32 v[38:39], v[38:39], v[56:57]
    v_cvt_pk_bf16_f32 v87, v30, v31
    buffer_load_dwordx4 v122, s[28:31], s54 offen offset:2048 lds
    v_pk_add_f32 v[40:41], v[40:41], v[60:61]
    v_pk_add_f32 v[42:43], v[42:43], v[60:61]
    v_pk_add_f32 v[44:45], v[44:45], v[60:61]
    v_pk_add_f32 v[46:47], v[46:47], v[60:61]
    v_exp_f32 v32, v32
    v_exp_f32 v33, v33
    v_exp_f32 v34, v34
    buffer_load_dwordx4 v123, s[28:31], s54 offen offset:3072 lds
    v_cvt_pk_bf16_f32 v88, v32, v33
    v_pk_mov_b32 v[50:51], v[48:49], v[48:49]
    v_pk_mov_b32 v[54:55], v[52:53], v[52:53]
    v_pk_mov_b32 v[58:59], v[56:57], v[56:57]
    v_pk_mov_b32 v[62:63], v[60:61], v[60:61]
    v_add_u32 v12, s49, v13
    s_lshl_b32 s51, s3, 2
    s_add_u32 s51, s51, 148480
    v_add_u32 v14, s51, v13
    s_lshl_b32 s84, s80, 15
    s_mov_b64 exec, 1
    buffer_atomic_or v99, v99, s[64:67], s77 offen sc1
    buffer_atomic_or v99, v99, s[64:67], s86 offen sc1
    s_mov_b64 exec, -1
    s_mov_b32 s56, 0
L_loop:
    s_and_b32 s54, s60, 0x1e000
    s_waitcnt lgkmcnt(7)
    v_mfma_f32_16x16x32_bf16 v[128:131], a[224:227], v[80:83], v[128:131]
    v_exp_f32 v35, v35
    v_mfma_f32_16x16x32_bf16 v[136:139], a[224:227], v[84:87], v[136:139]
    ds_read_b64_tr_b16 a[254:255], v111 offset:12288
    v_mfma_f32_16x16x32_bf16 a[96:99], a[116:119], v[80:83], a[96:99]
    s_waitcnt vmcnt(8)
    s_add_u32 m0, s49, 0
    v_mfma_f32_16x16x32_bf16 v[132:135], a[228:231], v[80:83], v[132:135]
    v_exp_f32 v36, v36
    v_mfma_f32_16x16x32_bf16 v[140:143], a[228:231], v[84:87], v[140:143]
    ds_read_b128 a[192:195], v100 offset:16384
    v_cvt_pk_bf16_f32 v89, v34, v35
    v_mfma_f32_16x16x32_bf16 v[144:147], a[232:235], v[80:83], v[144:147]
    ds_read_b128 a[196:199], v100 offset:20480
    v_exp_f32 v37, v37
    v_mfma_f32_16x16x32_bf16 v[152:155], a[232:235], v[84:87], v[152:155]
    buffer_load_dwordx4 v112, s[24:27], s54 offen offset:0 lds
    v_mfma_f32_16x16x32_bf16 v[148:151], a[236:239], v[80:83], v[148:151]
    v_exp_f32 v38, v38
    v_mfma_f32_16x16x32_bf16 v[156:159], a[236:239], v[84:87], v[156:159]
    ds_read_b128 a[200:203], v101 offset:16384
    v_cvt_pk_bf16_f32 v90, v36, v37
    v_mfma_f32_16x16x32_bf16 a[100:103], a[116:119], v[84:87], a[100:103]
    s_waitcnt lgkmcnt(3)
    v_mfma_f32_16x16x32_bf16 v[160:163], a[240:243], v[80:83], v[160:163]
    ds_read_b128 a[204:207], v101 offset:20480
    v_exp_f32 v39, v39
    v_mfma_f32_16x16x32_bf16 v[168:171], a[240:243], v[84:87], v[168:171]
    buffer_load_dwordx4 v113, s[24:27], s54 offen offset:1024 lds
    v_mfma_f32_16x16x32_bf16 v[164:167], a[244:247], v[80:83], v[164:167]
    v_exp_f32 v40, v40
    v_mfma_f32_16x16x32_bf16 v[172:175], a[244:247], v[84:87], v[172:175]
    ds_read_b128 a[208:211], v102 offset:16384
    v_cvt_pk_bf16_f32 v91, v38, v39
    v_mfma_f32_16x16x32_bf16 v[176:179], a[248:251], v[80:83], v[176:179]
    ds_read_b128 a[212:215], v102 offset:20480
    v_exp_f32 v41, v41
    v_mfma_f32_16x16x32_bf16 v[184:187], a[248:251], v[84:87], v[184:187]
    buffer_load_dwordx4 v114, s[24:27], s54 offen offset:2048 lds
    v_mfma_f32_16x16x32_bf16 v[180:183], a[252:255], v[80:83], v[180:183]
    v_exp_f32 v42, v42
    v_mfma_f32_16x16x32_bf16 v[188:191], a[252:255], v[84:87], v[188:191]
    ds_read_b128 a[216:219], v103 offset:16384
    v_cvt_pk_bf16_f32 v92, v40, v41
    s_waitcnt lgkmcnt(3)
    v_mfma_f32_16x16x32_bf16 v[16:19], a[192:195], a[128:131], v[48:51]
    ds_read_b128 a[220:223], v103 offset:20480
    v_exp_f32 v43, v43
    v_mfma_f32_16x16x32_bf16 v[20:23], a[196:199], a[128:131], v[48:51]
    buffer_load_dwordx4 v115, s[24:27], s54 offen offset:3072 lds
    v_mfma_f32_16x16x32_bf16 v[16:19], a[200:203], a[132:135], v[16:19]
    v_exp_f32 v44, v44
    v_mfma_f32_16x16x32_bf16 v[20:23], a[204:207], a[132:135], v[20:23]
    v_cvt_pk_bf16_f32 v93, v42, v43
    s_add_u32 m0, s49, 4096
    s_waitcnt lgkmcnt(0)
    v_mfma_f32_16x16x32_bf16 v[16:19], a[208:211], a[136:139], v[16:19]
    v_exp_f32 v45, v45
    v_mfma_f32_16x16x32_bf16 v[20:23], a[212:215], a[136:139], v[20:23]
    buffer_load_dwordx4 v116, s[24:27], s54 offen offset:0 lds
    v_mfma_f32_16x16x32_bf16 v[16:19], a[216:219], a[140:143], v[16:19]
    v_exp_f32 v46, v46
    v_mfma_f32_16x16x32_bf16 v[20:23], a[220:223], a[140:143], v[20:23]
    v_cvt_pk_bf16_f32 v94, v44, v45
    s_lshr_b64 s[60:61], s[60:61], 4
    v_mfma_f32_16x16x32_bf16 v[24:27], a[192:195], a[144:147], v[52:55]
    v_exp_f32 v47, v47
    v_mfma_f32_16x16x32_bf16 v[28:31], a[196:199], a[144:147], v[52:55]
    buffer_load_dwordx4 v117, s[24:27], s54 offen offset:1024 lds
    v_mfma_f32_16x16x32_bf16 v[24:27], a[200:203], a[148:151], v[24:27]
    v_exp_f32 v16, v16
    v_mfma_f32_16x16x32_bf16 v[28:31], a[204:207], a[148:151], v[28:31]
    v_cvt_pk_bf16_f32 v95, v46, v47
    v_mfma_f32_16x16x32_bf16 v[24:27], a[208:211], a[152:155], v[24:27]
    v_exp_f32 v17, v17
    v_mfma_f32_16x16x32_bf16 v[28:31], a[212:215], a[152:155], v[28:31]
    buffer_load_dwordx4 v118, s[24:27], s54 offen offset:2048 lds
    v_mfma_f32_16x16x32_bf16 v[24:27], a[216:219], a[156:159], v[24:27]
    v_exp_f32 v18, v18
    v_mfma_f32_16x16x32_bf16 v[28:31], a[220:223], a[156:159], v[28:31]
    v_cvt_pk_bf16_f32 v80, v16, v17
    v_mfma_f32_16x16x32_bf16 v[192:195], a[224:227], v[88:91], v[192:195]
    v_exp_f32 v19, v19
    v_mfma_f32_16x16x32_bf16 v[200:203], a[224:227], v[92:95], v[200:203]
    buffer_load_dwordx4 v119, s[24:27], s54 offen offset:3072 lds
    v_mfma_f32_16x16x32_bf16 a[104:107], a[116:119], v[88:91], a[104:107]
    s_waitcnt vmcnt(8)
    s_add_u32 m0, s49, 8192
    v_mfma_f32_16x16x32_bf16 v[196:199], a[228:231], v[88:91], v[196:199]
    v_exp_f32 v20, v20
    v_mfma_f32_16x16x32_bf16 v[204:207], a[228:231], v[92:95], v[204:207]
    ds_read_b64_tr_b16 a[224:225], v104 offset:24576
    v_cvt_pk_bf16_f32 v81, v18, v19
    v_mfma_f32_16x16x32_bf16 v[208:211], a[232:235], v[88:91], v[208:211]
    ds_read_b64_tr_b16 a[226:227], v104 offset:28672
    v_exp_f32 v21, v21
    v_mfma_f32_16x16x32_bf16 v[216:219], a[232:235], v[92:95], v[216:219]
    buffer_load_dwordx4 v120, s[28:31], s54 offen offset:0 lds
    v_mfma_f32_16x16x32_bf16 v[212:215], a[236:239], v[88:91], v[212:215]
    v_exp_f32 v22, v22
    v_mfma_f32_16x16x32_bf16 v[220:223], a[236:239], v[92:95], v[220:223]
    ds_read_b64_tr_b16 a[228:229], v105 offset:24576
    v_cvt_pk_bf16_f32 v82, v20, v21
    v_mfma_f32_16x16x32_bf16 v[224:227], a[240:243], v[88:91], v[224:227]
    ds_read_b64_tr_b16 a[230:231], v105 offset:28672
    v_exp_f32 v23, v23
    v_mfma_f32_16x16x32_bf16 v[232:235], a[240:243], v[92:95], v[232:235]
    buffer_load_dwordx4 v121, s[28:31], s54 offen offset:1024 lds
    v_mfma_f32_16x16x32_bf16 v[228:231], a[244:247], v[88:91], v[228:231]
    v_exp_f32 v24, v24
    v_mfma_f32_16x16x32_bf16 v[236:239], a[244:247], v[92:95], v[236:239]
    ds_read_b64_tr_b16 a[232:233], v106 offset:24576
    v_cvt_pk_bf16_f32 v83, v22, v23
    v_mfma_f32_16x16x32_bf16 v[240:243], a[248:251], v[88:91], v[240:243]
    ds_read_b64_tr_b16 a[234:235], v106 offset:28672
    v_exp_f32 v25, v25
    v_mfma_f32_16x16x32_bf16 v[248:251], a[248:251], v[92:95], v[248:251]
    buffer_load_dwordx4 v120, s[28:31], s54 offen offset:2048 lds
    v_mfma_f32_16x16x32_bf16 v[244:247], a[252:255], v[88:91], v[244:247]
    v_exp_f32 v26, v26
    v_mfma_f32_16x16x32_bf16 v[252:255], a[252:255], v[92:95], v[252:255]
    ds_read_b64_tr_b16 a[236:237], v107 offset:24576
    v_cvt_pk_bf16_f32 v84, v24, v25
    v_mfma_f32_16x16x32_bf16 v[32:35], a[192:195], a[160:163], v[56:59]
    ds_read_b64_tr_b16 a[238:239], v107 offset:28672
    v_exp_f32 v27, v27
    v_mfma_f32_16x16x32_bf16 v[36:39], a[196:199], a[160:163], v[56:59]
    buffer_load_dwordx4 v121, s[28:31], s54 offen offset:3072 lds
    v_mfma_f32_16x16x32_bf16 a[108:111], a[116:119], v[92:95], a[108:111]
    s_add_u32 m0, s49, 12288
    v_mfma_f32_16x16x32_bf16 v[32:35], a[200:203], a[164:167], v[32:35]
    v_exp_f32 v28, v28
    v_mfma_f32_16x16x32_bf16 v[36:39], a[204:207], a[164:167], v[36:39]
    ds_read_b64_tr_b16 a[240:241], v108 offset:24576
    v_cvt_pk_bf16_f32 v85, v26, v27
    v_mfma_f32_16x16x32_bf16 v[32:35], a[208:211], a[168:171], v[32:35]
    ds_read_b64_tr_b16 a[242:243], v108 offset:28672
    v_exp_f32 v29, v29
    v_mfma_f32_16x16x32_bf16 v[36:39], a[212:215], a[168:171], v[36:39]
    buffer_load_dwordx4 v122, s[28:31], s54 offen offset:0 lds
    v_mfma_f32_16x16x32_bf16 v[32:35], a[216:219], a[172:175], v[32:35]
    v_exp_f32 v30, v30
    v_mfma_f32_16x16x32_bf16 v[36:39], a[220:223], a[172:175], v[36:39]
    ds_read_b64_tr_b16 a[244:245], v109 offset:24576
    v_cvt_pk_bf16_f32 v86, v28, v29
    v_mfma_f32_16x16x32_bf16 v[40:43], a[192:195], a[176:179], v[60:63]
    ds_read_b64_tr_b16 a[246:247], v109 offset:28672
    v_exp_f32 v31, v31
    v_mfma_f32_16x16x32_bf16 v[44:47], a[196:199], a[176:179], v[60:63]
    buffer_load_dwordx4 v123, s[28:31], s54 offen offset:1024 lds
    v_mfma_f32_16x16x32_bf16 v[40:43], a[200:203], a[180:183], v[40:43]
    v_exp_f32 v32, v32
    v_mfma_f32_16x16x32_bf16 v[44:47], a[204:207], a[180:183], v[44:47]
    ds_read_b64_tr_b16 a[248:249], v110 offset:24576
    v_cvt_pk_bf16_f32 v87, v30, v31
    v_mfma_f32_16x16x32_bf16 v[40:43], a[208:211], a[184:187], v[40:43]
    ds_read_b64_tr_b16 a[250:251], v110 offset:28672
    v_exp_f32 v33, v33
    v_mfma_f32_16x16x32_bf16 v[44:47], a[212:215], a[184:187], v[44:47]
    buffer_load_dwordx4 v122, s[28:31], s54 offen offset:2048 lds
    v_mfma_f32_16x16x32_bf16 v[40:43], a[216:219], a[188:191], v[40:43]
    ds_read_b64_tr_b16 a[252:253], v111 offset:24576
    v_exp_f32 v34, v34
    v_mfma_f32_16x16x32_bf16 v[44:47], a[220:223], a[188:191], v[44:47]
    v_cvt_pk_bf16_f32 v88, v32, v33
    buffer_load_dwordx4 v123, s[28:31], s54 offen offset:3072 lds
    s_and_b32 s54, s60, 0x1e000
    s_waitcnt lgkmcnt(7)
    v_mfma_f32_16x16x32_bf16 v[128:131], a[224:227], v[80:83], v[128:131]
    v_exp_f32 v35, v35
    v_mfma_f32_16x16x32_bf16 v[136:139], a[224:227], v[84:87], v[136:139]
    ds_read_b64_tr_b16 a[254:255], v111 offset:28672
    v_mfma_f32_16x16x32_bf16 a[96:99], a[116:119], v[80:83], a[96:99]
    s_waitcnt vmcnt(8)
    s_add_u32 m0, s49, 16384
    v_mfma_f32_16x16x32_bf16 v[132:135], a[228:231], v[80:83], v[132:135]
    v_exp_f32 v36, v36
    v_mfma_f32_16x16x32_bf16 v[140:143], a[228:231], v[84:87], v[140:143]
    ds_read_b128 a[192:195], v100 offset:0
    v_cvt_pk_bf16_f32 v89, v34, v35
    v_mfma_f32_16x16x32_bf16 v[144:147], a[232:235], v[80:83], v[144:147]
    ds_read_b128 a[196:199], v100 offset:4096
    v_exp_f32 v37, v37
    v_mfma_f32_16x16x32_bf16 v[152:155], a[232:235], v[84:87], v[152:155]
    buffer_load_dwordx4 v112, s[24:27], s54 offen offset:0 lds
    v_mfma_f32_16x16x32_bf16 v[148:151], a[236:239], v[80:83], v[148:151]
    v_exp_f32 v38, v38
    v_mfma_f32_16x16x32_bf16 v[156:159], a[236:239], v[84:87], v[156:159]
    ds_read_b128 a[200:203], v101 offset:0
    v_cvt_pk_bf16_f32 v90, v36, v37
    v_mfma_f32_16x16x32_bf16 a[100:103], a[116:119], v[84:87], a[100:103]
    s_waitcnt lgkmcnt(3)
    v_mfma_f32_16x16x32_bf16 v[160:163], a[240:243], v[80:83], v[160:163]
    ds_read_b128 a[204:207], v101 offset:4096
    v_exp_f32 v39, v39
    v_mfma_f32_16x16x32_bf16 v[168:171], a[240:243], v[84:87], v[168:171]
    buffer_load_dwordx4 v113, s[24:27], s54 offen offset:1024 lds
    v_mfma_f32_16x16x32_bf16 v[164:167], a[244:247], v[80:83], v[164:167]
    v_exp_f32 v40, v40
    v_mfma_f32_16x16x32_bf16 v[172:175], a[244:247], v[84:87], v[172:175]
    ds_read_b128 a[208:211], v102 offset:0
    v_cvt_pk_bf16_f32 v91, v38, v39
    v_mfma_f32_16x16x32_bf16 v[176:179], a[248:251], v[80:83], v[176:179]
    ds_read_b128 a[212:215], v102 offset:4096
    v_exp_f32 v41, v41
    v_mfma_f32_16x16x32_bf16 v[184:187], a[248:251], v[84:87], v[184:187]
    buffer_load_dwordx4 v114, s[24:27], s54 offen offset:2048 lds
    v_mfma_f32_16x16x32_bf16 v[180:183], a[252:255], v[80:83], v[180:183]
    v_exp_f32 v42, v42
    v_mfma_f32_16x16x32_bf16 v[188:191], a[252:255], v[84:87], v[188:191]
    ds_read_b128 a[216:219], v103 offset:0
    v_cvt_pk_bf16_f32 v92, v40, v41
    s_waitcnt lgkmcnt(3)
    v_mfma_f32_16x16x32_bf16 v[16:19], a[192:195], a[128:131], v[48:51]
    ds_read_b128 a[220:223], v103 offset:4096
    v_exp_f32 v43, v43
    v_mfma_f32_16x16x32_bf16 v[20:23], a[196:199], a[128:131], v[48:51]
    buffer_load_dwordx4 v115, s[24:27], s54 offen offset:3072 lds
    v_mfma_f32_16x16x32_bf16 v[16:19], a[200:203], a[132:135], v[16:19]
    v_exp_f32 v44, v44
    v_mfma_f32_16x16x32_bf16 v[20:23], a[204:207], a[132:135], v[20:23]
    v_cvt_pk_bf16_f32 v93, v42, v43
    s_add_u32 m0, s49, 20480
    s_waitcnt lgkmcnt(0)
    v_mfma_f32_16x16x32_bf16 v[16:19], a[208:211], a[136:139], v[16:19]
    v_exp_f32 v45, v45
    v_mfma_f32_16x16x32_bf16 v[20:23], a[212:215], a[136:139], v[20:23]
    buffer_load_dwordx4 v116, s[24:27], s54 offen offset:0 lds
    v_mfma_f32_16x16x32_bf16 v[16:19], a[216:219], a[140:143], v[16:19]
    v_exp_f32 v46, v46
    v_mfma_f32_16x16x32_bf16 v[20:23], a[220:223], a[140:143], v[20:23]
    v_cvt_pk_bf16_f32 v94, v44, v45
    s_lshr_b64 s[60:61], s[60:61], 4
    v_mfma_f32_16x16x32_bf16 v[24:27], a[192:195], a[144:147], v[52:55]
    v_exp_f32 v47, v47
    v_mfma_f32_16x16x32_bf16 v[28:31], a[196:199], a[144:147], v[52:55]
    buffer_load_dwordx4 v117, s[24:27], s54 offen offset:1024 lds
    v_mfma_f32_16x16x32_bf16 v[24:27], a[200:203], a[148:151], v[24:27]
    v_exp_f32 v16, v16
    v_mfma_f32_16x16x32_bf16 v[28:31], a[204:207], a[148:151], v[28:31]
    v_cvt_pk_bf16_f32 v95, v46, v47
    buffer_load_dword v98, v99, s[68:71], s72 offen sc1
    v_mfma_f32_16x16x32_bf16 v[24:27], a[208:211], a[152:155], v[24:27]
    v_exp_f32 v17, v17
    v_mfma_f32_16x16x32_bf16 v[28:31], a[212:215], a[152:155], v[28:31]
    buffer_load_dwordx4 v118, s[24:27], s54 offen offset:2048 lds
    v_mfma_f32_16x16x32_bf16 v[24:27], a[216:219], a[156:159], v[24:27]
    v_exp_f32 v18, v18
    v_mfma_f32_16x16x32_bf16 v[28:31], a[220:223], a[156:159], v[28:31]
    v_cvt_pk_bf16_f32 v80, v16, v17
    s_add_u32 s56, s56, 1
    v_mfma_f32_16x16x32_bf16 v[192:195], a[224:227], v[88:91], v[192:195]
    v_exp_f32 v19, v19
    v_mfma_f32_16x16x32_bf16 v[200:203], a[224:227], v[92:95], v[200:203]
    buffer_load_dwordx4 v119, s[24:27], s54 offen offset:3072 lds
    v_mfma_f32_16x16x32_bf16 a[104:107], a[116:119], v[88:91], a[104:107]
    s_waitcnt vmcnt(9)
    s_add_u32 m0, s49, 24576
    v_mfma_f32_16x16x32_bf16 v[196:199], a[228:231], v[88:91], v[196:199]
    v_exp_f32 v20, v20
    v_mfma_f32_16x16x32_bf16 v[204:207], a[228:231], v[92:95], v[204:207]
    ds_read_b64_tr_b16 a[224:225], v104 offset:8192
    v_cvt_pk_bf16_f32 v81, v18, v19
    v_mfma_f32_16x16x32_bf16 v[208:211], a[232:235], v[88:91], v[208:211]
    ds_read_b64_tr_b16 a[226:227], v104 offset:12288
    v_exp_f32 v21, v21
    v_mfma_f32_16x16x32_bf16 v[216:219], a[232:235], v[92:95], v[216:219]
    buffer_load_dwordx4 v120, s[28:31], s54 offen offset:0 lds
    v_mfma_f32_16x16x32_bf16 v[212:215], a[236:239], v[88:91], v[212:215]
    v_exp_f32 v22, v22
    v_mfma_f32_16x16x32_bf16 v[220:223], a[236:239], v[92:95], v[220:223]
    ds_read_b64_tr_b16 a[228:229], v105 offset:8192
    v_cvt_pk_bf16_f32 v82, v20, v21
    v_mfma_f32_16x16x32_bf16 v[224:227], a[240:243], v[88:91], v[224:227]
    ds_read_b64_tr_b16 a[230:231], v105 offset:12288
    v_exp_f32 v23, v23
    v_mfma_f32_16x16x32_bf16 v[232:235], a[240:243], v[92:95], v[232:235]
    buffer_load_dwordx4 v121, s[28:31], s54 offen offset:1024 lds
    v_mfma_f32_16x16x32_bf16 v[228:231], a[244:247], v[88:91], v[228:231]
    v_exp_f32 v24, v24
    v_mfma_f32_16x16x32_bf16 v[236:239], a[244:247], v[92:95], v[236:239]
    ds_read_b64_tr_b16 a[232:233], v106 offset:8192
    v_cvt_pk_bf16_f32 v83, v22, v23
    v_mfma_f32_16x16x32_bf16 v[240:243], a[248:251], v[88:91], v[240:243]
    ds_read_b64_tr_b16 a[234:235], v106 offset:12288
    v_exp_f32 v25, v25
    v_mfma_f32_16x16x32_bf16 v[248:251], a[248:251], v[92:95], v[248:251]
    buffer_load_dwordx4 v120, s[28:31], s54 offen offset:2048 lds
    v_mfma_f32_16x16x32_bf16 v[244:247], a[252:255], v[88:91], v[244:247]
    v_exp_f32 v26, v26
    v_mfma_f32_16x16x32_bf16 v[252:255], a[252:255], v[92:95], v[252:255]
    ds_read_b64_tr_b16 a[236:237], v107 offset:8192
    v_cvt_pk_bf16_f32 v84, v24, v25
    v_mfma_f32_16x16x32_bf16 v[32:35], a[192:195], a[160:163], v[56:59]
    ds_read_b64_tr_b16 a[238:239], v107 offset:12288
    v_exp_f32 v27, v27
    v_mfma_f32_16x16x32_bf16 v[36:39], a[196:199], a[160:163], v[56:59]
    buffer_load_dwordx4 v121, s[28:31], s54 offen offset:3072 lds
    v_mfma_f32_16x16x32_bf16 a[108:111], a[116:119], v[92:95], a[108:111]
    s_add_u32 m0, s49, 28672
    v_mfma_f32_16x16x32_bf16 v[32:35], a[200:203], a[164:167], v[32:35]
    v_exp_f32 v28, v28
    v_mfma_f32_16x16x32_bf16 v[36:39], a[204:207], a[164:167], v[36:39]
    ds_read_b64_tr_b16 a[240:241], v108 offset:8192
    v_cvt_pk_bf16_f32 v85, v26, v27
    v_mfma_f32_16x16x32_bf16 v[32:35], a[208:211], a[168:171], v[32:35]
    ds_read_b64_tr_b16 a[242:243], v108 offset:12288
    v_exp_f32 v29, v29
    v_mfma_f32_16x16x32_bf16 v[36:39], a[212:215], a[168:171], v[36:39]
    buffer_load_dwordx4 v122, s[28:31], s54 offen offset:0 lds
    v_mfma_f32_16x16x32_bf16 v[32:35], a[216:219], a[172:175], v[32:35]
    v_exp_f32 v30, v30
    v_mfma_f32_16x16x32_bf16 v[36:39], a[220:223], a[172:175], v[36:39]
    ds_read_b64_tr_b16 a[244:245], v109 offset:8192
    v_cvt_pk_bf16_f32 v86, v28, v29
    v_mfma_f32_16x16x32_bf16 v[40:43], a[192:195], a[176:179], v[60:63]
    ds_read_b64_tr_b16 a[246:247], v109 offset:12288
    v_exp_f32 v31, v31
    v_mfma_f32_16x16x32_bf16 v[44:47], a[196:199], a[176:179], v[60:63]
    buffer_load_dwordx4 v123, s[28:31], s54 offen offset:1024 lds
    v_mfma_f32_16x16x32_bf16 v[40:43], a[200:203], a[180:183], v[40:43]
    v_exp_f32 v32, v32
    v_mfma_f32_16x16x32_bf16 v[44:47], a[204:207], a[180:183], v[44:47]
    ds_read_b64_tr_b16 a[248:249], v110 offset:8192
    v_cvt_pk_bf16_f32 v87, v30, v31
    v_mfma_f32_16x16x32_bf16 v[40:43], a[208:211], a[184:187], v[40:43]
    ds_read_b64_tr_b16 a[250:251], v110 offset:12288
    v_exp_f32 v33, v33
    v_mfma_f32_16x16x32_bf16 v[44:47], a[212:215], a[184:187], v[44:47]
    buffer_load_dwordx4 v122, s[28:31], s54 offen offset:2048 lds
    v_mfma_f32_16x16x32_bf16 v[40:43], a[216:219], a[188:191], v[40:43]
    ds_read_b64_tr_b16 a[252:253], v111 offset:8192
    v_exp_f32 v34, v34
    v_mfma_f32_16x16x32_bf16 v[44:47], a[220:223], a[188:191], v[44:47]
    v_cvt_pk_bf16_f32 v88, v32, v33
    buffer_load_dwordx4 v123, s[28:31], s54 offen offset:3072 lds
    s_cmp_lt_u32 s56, 3
    s_cbranch_scc1 L_loop
    s_waitcnt lgkmcnt(7)
    v_mfma_f32_16x16x32_bf16 v[128:131], a[224:227], v[80:83], v[128:131]
    v_exp_f32 v35, v35
    v_mfma_f32_16x16x32_bf16 v[136:139], a[224:227], v[84:87], v[136:139]
    ds_read_b64_tr_b16 a[254:255], v111 offset:12288
    v_mov_b32 v112, v1
    v_add_u32 v113, 7168, v1
    v_mfma_f32_16x16x32_bf16 a[96:99], a[116:119], v[80:83], a[96:99]
    s_waitcnt vmcnt(8)
    v_mfma_f32_16x16x32_bf16 v[132:135], a[228:231], v[80:83], v[132:135]
    v_exp_f32 v36, v36
    v_mfma_f32_16x16x32_bf16 v[140:143], a[228:231], v[84:87], v[140:143]
    ds_read_b128 a[192:195], v100 offset:16384
    v_cvt_pk_bf16_f32 v89, v34, v35
    v_add_u32 v114, 14336, v1
    v_add_u32 v115, 21504, v1
    v_mfma_f32_16x16x32_bf16 v[144:147], a[232:235], v[80:83], v[144:147]
    v_exp_f32 v37, v37
    v_mfma_f32_16x16x32_bf16 v[152:155], a[232:235], v[84:87], v[152:155]
    ds_read_b128 a[196:199], v100 offset:20480
    s_add_u32 m0, s49, 0
    v_mfma_f32_16x16x32_bf16 v[148:151], a[236:239], v[80:83], v[148:151]
    ds_read_b128 a[200:203], v101 offset:16384
    v_exp_f32 v38, v38
    v_mfma_f32_16x16x32_bf16 v[156:159], a[236:239], v[84:87], v[156:159]
    v_cvt_pk_bf16_f32 v90, v36, v37
    buffer_load_dwordx4 v112, s[36:39], s84 offen offset:0 lds
    v_mfma_f32_16x16x32_bf16 a[100:103], a[116:119], v[84:87], a[100:103]
    s_waitcnt lgkmcnt(3)
    v_mfma_f32_16x16x32_bf16 v[160:163], a[240:243], v[80:83], v[160:163]
    ds_read_b128 a[204:207], v101 offset:20480
    v_exp_f32 v39, v39
    v_mfma_f32_16x16x32_bf16 v[168:171], a[240:243], v[84:87], v[168:171]
    buffer_load_dwordx4 v113, s[36:39], s84 offen offset:1024 lds
    v_mfma_f32_16x16x32_bf16 v[164:167], a[244:247], v[80:83], v[164:167]
    ds_read_b128 a[208:211], v102 offset:16384
    v_exp_f32 v40, v40
    v_mfma_f32_16x16x32_bf16 v[172:175], a[244:247], v[84:87], v[172:175]
    v_cvt_pk_bf16_f32 v91, v38, v39
    buffer_load_dwordx4 v114, s[36:39], s84 offen offset:2048 lds
    v_mfma_f32_16x16x32_bf16 v[176:179], a[248:251], v[80:83], v[176:179]
    ds_read_b128 a[212:215], v102 offset:20480
    v_exp_f32 v41, v41
    v_mfma_f32_16x16x32_bf16 v[184:187], a[248:251], v[84:87], v[184:187]
    buffer_load_dwordx4 v115, s[36:39], s84 offen offset:3072 lds
    v_mfma_f32_16x16x32_bf16 v[180:183], a[252:255], v[80:83], v[180:183]
    v_exp_f32 v42, v42
    v_mfma_f32_16x16x32_bf16 v[188:191], a[252:255], v[84:87], v[188:191]
    ds_read_b128 a[216:219], v103 offset:16384
    v_cvt_pk_bf16_f32 v92, v40, v41
    s_add_u32 s84, s84, 0x8000
    s_waitcnt lgkmcnt(3)
    v_mfma_f32_16x16x32_bf16 v[16:19], a[192:195], a[128:131], v[48:51]
    v_exp_f32 v43, v43
    v_mfma_f32_16x16x32_bf16 v[20:23], a[196:199], a[128:131], v[48:51]
    ds_read_b128 a[220:223], v103 offset:20480
    s_and_b32 s84, s84, 0x3ffff
    v_mfma_f32_16x16x32_bf16 v[16:19], a[200:203], a[132:135], v[16:19]
    v_exp_f32 v44, v44
    v_mfma_f32_16x16x32_bf16 v[20:23], a[204:207], a[132:135], v[20:23]
    v_cvt_pk_bf16_f32 v93, v42, v43
    v_xor_b32 v101, 32768, v12
    s_waitcnt lgkmcnt(0)
    v_mfma_f32_16x16x32_bf16 v[16:19], a[208:211], a[136:139], v[16:19]
    v_exp_f32 v45, v45
    v_mfma_f32_16x16x32_bf16 v[20:23], a[212:215], a[136:139], v[20:23]
    v_xor_b32 v102, 65536, v12
    v_mfma_f32_16x16x32_bf16 v[16:19], a[216:219], a[140:143], v[16:19]
    v_exp_f32 v46, v46
    v_mfma_f32_16x16x32_bf16 v[20:23], a[220:223], a[140:143], v[20:23]
    v_cvt_pk_bf16_f32 v94, v44, v45
    v_xor_b32 v103, 98304, v12
    v_mfma_f32_16x16x32_bf16 v[24:27], a[192:195], a[144:147], v[52:55]
    v_exp_f32 v47, v47
    v_mfma_f32_16x16x32_bf16 v[28:31], a[196:199], a[144:147], v[52:55]
    s_add_u32 m0, s49, 4096
    v_mfma_f32_16x16x32_bf16 v[24:27], a[200:203], a[148:151], v[24:27]
    v_exp_f32 v16, v16
    v_mfma_f32_16x16x32_bf16 v[28:31], a[204:207], a[148:151], v[28:31]
    v_cvt_pk_bf16_f32 v95, v46, v47
    buffer_load_dwordx4 v112, s[36:39], s84 offen offset:0 lds
    v_mfma_f32_16x16x32_bf16 v[24:27], a[208:211], a[152:155], v[24:27]
    v_exp_f32 v17, v17
    v_mfma_f32_16x16x32_bf16 v[28:31], a[212:215], a[152:155], v[28:31]
    buffer_load_dwordx4 v113, s[36:39], s84 offen offset:1024 lds
    v_mfma_f32_16x16x32_bf16 v[24:27], a[216:219], a[156:159], v[24:27]
    v_exp_f32 v18, v18
    v_mfma_f32_16x16x32_bf16 v[28:31], a[220:223], a[156:159], v[28:31]
    v_cvt_pk_bf16_f32 v80, v16, v17
    buffer_load_dwordx4 v114, s[36:39], s84 offen offset:2048 lds
    v_mfma_f32_16x16x32_bf16 v[192:195], a[224:227], v[88:91], v[192:195]
    v_exp_f32 v19, v19
    v_mfma_f32_16x16x32_bf16 v[200:203], a[224:227], v[92:95], v[200:203]
    buffer_load_dwordx4 v115, s[36:39], s84 offen offset:3072 lds
    v_mfma_f32_16x16x32_bf16 a[104:107], a[116:119], v[88:91], a[104:107]
    s_waitcnt vmcnt(8)
    v_mfma_f32_16x16x32_bf16 v[196:199], a[228:231], v[88:91], v[196:199]
    v_exp_f32 v20, v20
    v_mfma_f32_16x16x32_bf16 v[204:207], a[228:231], v[92:95], v[204:207]
    ds_read_b64_tr_b16 a[224:225], v104 offset:24576
    v_cvt_pk_bf16_f32 v81, v18, v19
    s_add_u32 s84, s84, 0x8000
    v_mfma_f32_16x16x32_bf16 v[208:211], a[232:235], v[88:91], v[208:211]
    v_exp_f32 v21, v21
    v_mfma_f32_16x16x32_bf16 v[216:219], a[232:235], v[92:95], v[216:219]
    ds_read_b64_tr_b16 a[226:227], v104 offset:28672
    s_and_b32 s84, s84, 0x3ffff
    v_mfma_f32_16x16x32_bf16 v[212:215], a[236:239], v[88:91], v[212:215]
    v_exp_f32 v22, v22
    v_mfma_f32_16x16x32_bf16 v[220:223], a[236:239], v[92:95], v[220:223]
    ds_read_b64_tr_b16 a[228:229], v105 offset:24576
    v_cvt_pk_bf16_f32 v82, v20, v21
    v_mfma_f32_16x16x32_bf16 v[224:227], a[240:243], v[88:91], v[224:227]
    v_exp_f32 v23, v23
    v_mfma_f32_16x16x32_bf16 v[232:235], a[240:243], v[92:95], v[232:235]
    ds_read_b64_tr_b16 a[230:231], v105 offset:28672
    v_readfirstlane_b32 s73, v98
    v_mfma_f32_16x16x32_bf16 v[228:231], a[244:247], v[88:91], v[228:231]
    v_exp_f32 v24, v24
    v_mfma_f32_16x16x32_bf16 v[236:239], a[244:247], v[92:95], v[236:239]
    ds_read_b64_tr_b16 a[232:233], v106 offset:24576
    v_cvt_pk_bf16_f32 v83, v22, v23
    v_mfma_f32_16x16x32_bf16 v[240:243], a[248:251], v[88:91], v[240:243]
    v_exp_f32 v25, v25
    v_mfma_f32_16x16x32_bf16 v[248:251], a[248:251], v[92:95], v[248:251]
    ds_read_b64_tr_b16 a[234:235], v106 offset:28672
    s_add_u32 m0, s49, 8192
    v_mfma_f32_16x16x32_bf16 v[244:247], a[252:255], v[88:91], v[244:247]
    ds_read_b64_tr_b16 a[236:237], v107 offset:24576
    v_exp_f32 v26, v26
    v_mfma_f32_16x16x32_bf16 v[252:255], a[252:255], v[92:95], v[252:255]
    v_cvt_pk_bf16_f32 v84, v24, v25
    buffer_load_dwordx4 v112, s[36:39], s84 offen offset:0 lds
    v_mfma_f32_16x16x32_bf16 v[32:35], a[192:195], a[160:163], v[56:59]
    ds_read_b64_tr_b16 a[238:239], v107 offset:28672
    v_exp_f32 v27, v27
    v_mfma_f32_16x16x32_bf16 v[36:39], a[196:199], a[160:163], v[56:59]
    buffer_load_dwordx4 v113, s[36:39], s84 offen offset:1024 lds
    v_mfma_f32_16x16x32_bf16 a[108:111], a[116:119], v[92:95], a[108:111]
    v_mfma_f32_16x16x32_bf16 v[32:35], a[200:203], a[164:167], v[32:35]
    ds_read_b64_tr_b16 a[240:241], v108 offset:24576
    v_exp_f32 v28, v28
    v_mfma_f32_16x16x32_bf16 v[36:39], a[204:207], a[164:167], v[36:39]
    v_cvt_pk_bf16_f32 v85, v26, v27
    buffer_load_dwordx4 v114, s[36:39], s84 offen offset:2048 lds
    v_mfma_f32_16x16x32_bf16 v[32:35], a[208:211], a[168:171], v[32:35]
    ds_read_b64_tr_b16 a[242:243], v108 offset:28672
    v_exp_f32 v29, v29
    v_mfma_f32_16x16x32_bf16 v[36:39], a[212:215], a[168:171], v[36:39]
    buffer_load_dwordx4 v115, s[36:39], s84 offen offset:3072 lds
    v_mfma_f32_16x16x32_bf16 v[32:35], a[216:219], a[172:175], v[32:35]
    v_exp_f32 v30, v30
    v_mfma_f32_16x16x32_bf16 v[36:39], a[220:223], a[172:175], v[36:39]
    ds_read_b64_tr_b16 a[244:245], v109 offset:24576
    v_cvt_pk_bf16_f32 v86, v28, v29
    s_add_u32 s84, s84, 0x8000
    v_mfma_f32_16x16x32_bf16 v[40:43], a[192:195], a[176:179], v[60:63]
    v_exp_f32 v31, v31
    v_mfma_f32_16x16x32_bf16 v[44:47], a[196:199], a[176:179], v[60:63]
    ds_read_b64_tr_b16 a[246:247], v109 offset:28672
    s_and_b32 s84, s84, 0x3ffff
    v_mfma_f32_16x16x32_bf16 v[40:43], a[200:203], a[180:183], v[40:43]
    v_exp_f32 v32, v32
    v_mfma_f32_16x16x32_bf16 v[44:47], a[204:207], a[180:183], v[44:47]
    ds_read_b64_tr_b16 a[248:249], v110 offset:24576
    v_cvt_pk_bf16_f32 v87, v30, v31
    v_mfma_f32_16x16x32_bf16 v[40:43], a[208:211], a[184:187], v[40:43]
    v_exp_f32 v33, v33
    v_mfma_f32_16x16x32_bf16 v[44:47], a[212:215], a[184:187], v[44:47]
    ds_read_b64_tr_b16 a[250:251], v110 offset:28672
    v_mfma_f32_16x16x32_bf16 v[40:43], a[216:219], a[188:191], v[40:43]
    v_exp_f32 v34, v34
    v_mfma_f32_16x16x32_bf16 v[44:47], a[220:223], a[188:191], v[44:47]
    ds_read_b64_tr_b16 a[252:253], v111 offset:24576
    v_cvt_pk_bf16_f32 v88, v32, v33
    s_waitcnt lgkmcnt(7)
    v_mfma_f32_16x16x32_bf16 v[144:147], a[232:235], v[80:83], v[144:147]
    ds_read_b64_tr_b16 a[254:255], v111 offset:28672
    v_exp_f32 v35, v35
    v_mfma_f32_16x16x32_bf16 v[152:155], a[232:235], v[84:87], v[152:155]
    v_exp_f32 v36, v36
    v_cvt_pk_bf16_f32 v89, v34, v35
    v_mfma_f32_16x16x32_bf16 v[148:151], a[236:239], v[80:83], v[148:151]
    v_exp_f32 v37, v37
    v_mfma_f32_16x16x32_bf16 v[156:159], a[236:239], v[84:87], v[156:159]
    v_exp_f32 v38, v38
    v_cvt_pk_bf16_f32 v90, v36, v37
    s_waitcnt lgkmcnt(1)
    v_mfma_f32_16x16x32_bf16 v[160:163], a[240:243], v[80:83], v[160:163]
    v_exp_f32 v39, v39
    v_mfma_f32_16x16x32_bf16 v[168:171], a[240:243], v[84:87], v[168:171]
    v_exp_f32 v40, v40
    v_cvt_pk_bf16_f32 v91, v38, v39
    v_mfma_f32_16x16x32_bf16 v[164:167], a[244:247], v[80:83], v[164:167]
    v_exp_f32 v41, v41
    v_exp_f32 v42, v42
    v_mfma_f32_16x16x32_bf16 v[172:175], a[244:247], v[84:87], v[172:175]
    v_cvt_pk_bf16_f32 v144, v144, v145
    v_cvt_pk_bf16_f32 v145, v146, v147
    v_cvt_pk_bf16_f32 v146, v148, v149
    v_cvt_pk_bf16_f32 v147, v150, v151
    v_mfma_f32_16x16x32_bf16 v[176:179], a[248:251], v[80:83], v[176:179]
    v_cvt_pk_bf16_f32 v92, v40, v41
    v_exp_f32 v43, v43
    v_mfma_f32_16x16x32_bf16 v[184:187], a[248:251], v[84:87], v[184:187]
    v_exp_f32 v44, v44
    ds_write_b128 v12, v[144:147] offset:16384
    v_cvt_pk_bf16_f32 v148, v152, v153
    v_cvt_pk_bf16_f32 v149, v154, v155
    v_cvt_pk_bf16_f32 v150, v156, v157
    s_waitcnt lgkmcnt(1)
    v_mfma_f32_16x16x32_bf16 v[180:183], a[252:255], v[80:83], v[180:183]
    v_cvt_pk_bf16_f32 v93, v42, v43
    v_exp_f32 v45, v45
    v_mfma_f32_16x16x32_bf16 v[188:191], a[252:255], v[84:87], v[188:191]
    v_exp_f32 v46, v46
    v_cvt_pk_bf16_f32 v151, v158, v159
    ds_write_b128 v12, v[148:151] offset:17408
    v_cvt_pk_bf16_f32 v160, v160, v161
    v_cvt_pk_bf16_f32 v161, v162, v163
    v_mfma_f32_16x16x32_bf16 v[128:131], a[224:227], v[80:83], v[128:131]
    v_cvt_pk_bf16_f32 v94, v44, v45
    v_exp_f32 v47, v47
    v_mfma_f32_16x16x32_bf16 v[136:139], a[224:227], v[84:87], v[136:139]
    v_cvt_pk_bf16_f32 v162, v164, v165
    v_cvt_pk_bf16_f32 v163, v166, v167
    ds_write_b128 v12, v[160:163] offset:20480
    v_cvt_pk_bf16_f32 v164, v168, v169
    v_mfma_f32_16x16x32_bf16 a[96:99], a[116:119], v[80:83], a[96:99]
    v_mfma_f32_16x16x32_bf16 v[132:135], a[228:231], v[80:83], v[132:135]
    v_cvt_pk_bf16_f32 v95, v46, v47
    v_cvt_pk_bf16_f32 v165, v170, v171
    v_mfma_f32_16x16x32_bf16 v[140:143], a[228:231], v[84:87], v[140:143]
    v_cvt_pk_bf16_f32 v166, v172, v173
    v_cvt_pk_bf16_f32 v167, v174, v175
    ds_write_b128 v12, v[164:167] offset:21504
    v_mfma_f32_16x16x32_bf16 a[100:103], a[116:119], v[84:87], a[100:103]
    v_mfma_f32_16x16x32_bf16 a[104:107], a[116:119], v[88:91], a[104:107]
    v_mfma_f32_16x16x32_bf16 v[208:211], a[232:235], v[88:91], v[208:211]
    v_cvt_pk_bf16_f32 v176, v176, v177
    v_cvt_pk_bf16_f32 v177, v178, v179
    v_mfma_f32_16x16x32_bf16 v[216:219], a[232:235], v[92:95], v[216:219]
    v_cvt_pk_bf16_f32 v178, v180, v181
    v_cvt_pk_bf16_f32 v179, v182, v183
    ds_write_b128 v12, v[176:179] offset:24576
    v_mfma_f32_16x16x32_bf16 a[108:111], a[116:119], v[92:95], a[108:111]
    v_mfma_f32_16x16x32_bf16 v[212:215], a[236:239], v[88:91], v[212:215]
    v_cvt_pk_bf16_f32 v180, v184, v185
    v_cvt_pk_bf16_f32 v181, v186, v187
    v_mfma_f32_16x16x32_bf16 v[220:223], a[236:239], v[92:95], v[220:223]
    v_cvt_pk_bf16_f32 v182, v188, v189
    v_cvt_pk_bf16_f32 v183, v190, v191
    v_mfma_f32_16x16x32_bf16 v[224:227], a[240:243], v[88:91], v[224:227]
    ds_write_b128 v12, v[180:183] offset:25600
    v_cvt_pk_bf16_f32 v208, v208, v209
    v_mfma_f32_16x16x32_bf16 v[232:235], a[240:243], v[92:95], v[232:235]
    v_cvt_pk_bf16_f32 v209, v210, v211
    v_cvt_pk_bf16_f32 v210, v212, v213
    v_cvt_pk_bf16_f32 v211, v214, v215
    v_mfma_f32_16x16x32_bf16 v[228:231], a[244:247], v[88:91], v[228:231]
    ds_write_b128 v12, v[208:211] offset:18432
    v_cvt_pk_bf16_f32 v212, v216, v217
    v_cvt_pk_bf16_f32 v213, v218, v219
    v_cvt_pk_bf16_f32 v214, v220, v221
    v_mfma_f32_16x16x32_bf16 v[236:239], a[244:247], v[92:95], v[236:239]
    s_mov_b64 exec, 0xffff
    ds_write_b32 v14, a96 offset:0
    ds_write_b32 v14, a100 offset:256
    ds_write_b32 v14, a104 offset:512
    ds_write_b32 v14, a108 offset:768
    s_mov_b64 exec, -1
    v_mfma_f32_16x16x32_bf16 v[240:243], a[248:251], v[88:91], v[240:243]
    v_cvt_pk_bf16_f32 v215, v222, v223
    ds_write_b128 v12, v[212:215] offset:19456
    v_mfma_f32_16x16x32_bf16 v[248:251], a[248:251], v[92:95], v[248:251]
    v_cvt_pk_bf16_f32 v224, v224, v225
    v_cvt_pk_bf16_f32 v225, v226, v227
    v_mfma_f32_16x16x32_bf16 v[244:247], a[252:255], v[88:91], v[244:247]
    v_cvt_pk_bf16_f32 v226, v228, v229
    v_cvt_pk_bf16_f32 v227, v230, v231
    v_mfma_f32_16x16x32_bf16 v[252:255], a[252:255], v[92:95], v[252:255]
    ds_write_b128 v12, v[224:227] offset:22528
    v_cvt_pk_bf16_f32 v228, v232, v233
    v_cvt_pk_bf16_f32 v229, v234, v235
    v_mfma_f32_16x16x32_bf16 v[192:195], a[224:227], v[88:91], v[192:195]
    v_cvt_pk_bf16_f32 v230, v236, v237
    v_cvt_pk_bf16_f32 v231, v238, v239
    v_mfma_f32_16x16x32_bf16 v[200:203], a[224:227], v[92:95], v[200:203]
    ds_write_b128 v12, v[228:231] offset:23552
    v_cvt_pk_bf16_f32 v240, v240, v241
    v_mfma_f32_16x16x32_bf16 v[196:199], a[228:231], v[88:91], v[196:199]
    v_cvt_pk_bf16_f32 v241, v242, v243
    v_cvt_pk_bf16_f32 v242, v244, v245
    v_mfma_f32_16x16x32_bf16 v[204:207], a[228:231], v[92:95], v[204:207]
    v_cvt_pk_bf16_f32 v243, v246, v247
    ds_write_b128 v12, v[240:243] offset:26624
    v_cvt_pk_bf16_f32 v244, v248, v249
    v_cvt_pk_bf16_f32 v245, v250, v251
    v_cvt_pk_bf16_f32 v246, v252, v253
    v_cvt_pk_bf16_f32 v247, v254, v255
    ds_write_b128 v12, v[244:247] offset:27648
    s_waitcnt lgkmcnt(0)
    s_barrier
    ds_read_b128 v[16:19], v101 offset:16384
    ds_read_b128 v[24:27], v102 offset:20480
    ds_read_b128 v[32:35], v103 offset:24576
    ds_read_b128 v[80:83], v96 offset:1024
    ds_read_b128 v[84:87], v96 offset:1280
    ds_read_b128 v[88:91], v96 offset:1536
    ds_read_b128 v[92:95], v96 offset:1792
    ds_read_b128 v[20:23], v101 offset:17408
    ds_read_b128 v[28:31], v102 offset:21504
    ds_read_b128 v[36:39], v103 offset:25600
    ds_read_b128 v[40:43], v101 offset:18432
    ds_read_b128 v[48:51], v102 offset:22528
    ds_read_b128 v[56:59], v103 offset:26624
    s_add_u32 m0, s49, 12288
    s_nop 0
    buffer_load_dwordx4 v112, s[36:39], s84 offen offset:0 lds
    buffer_load_dwordx4 v113, s[36:39], s84 offen offset:1024 lds
    buffer_load_dwordx4 v114, s[36:39], s84 offen offset:2048 lds
    buffer_load_dwordx4 v115, s[36:39], s84 offen offset:3072 lds
    s_add_u32 s84, s84, 0x8000
    s_and_b32 s84, s84, 0x3ffff
    s_waitcnt lgkmcnt(10)
    v_mfma_f32_16x16x32_bf16 v[128:131], v[2:5], v[16:19], v[128:131]
    ds_read_b128 v[44:47], v101 offset:19456
    ds_read_b128 v[52:55], v102 offset:23552
    v_mfma_f32_16x16x32_bf16 v[132:135], v[4:7], v[16:19], v[132:135]
    ds_read_b128 v[60:63], v103 offset:27648
    s_waitcnt lgkmcnt(9)
    v_mfma_f32_16x16x32_bf16 v[128:131], v[2:5], v[24:27], v[128:131]
    v_add_f32 v80, v80, v81
    v_add_f32 v82, v82, v83
    v_mfma_f32_16x16x32_bf16 v[132:135], v[4:7], v[24:27], v[132:135]
    v_add_f32 v81, v80, v82
    v_rcp_f32 v80, v81
    v_mfma_f32_16x16x32_bf16 v[128:131], v[2:5], v[32:35], v[128:131]
    v_add_f32 v84, v84, v85
    v_add_f32 v86, v86, v87
    v_mfma_f32_16x16x32_bf16 v[132:135], v[4:7], v[32:35], v[132:135]
    v_add_f32 v85, v84, v86
    v_rcp_f32 v84, v85
    s_waitcnt lgkmcnt(6)
    v_mfma_f32_16x16x32_bf16 v[136:139], v[2:5], v[20:23], v[136:139]
    v_add_f32 v88, v88, v89
    v_add_f32 v90, v90, v91
    v_mfma_f32_16x16x32_bf16 v[140:143], v[4:7], v[20:23], v[140:143]
    v_add_f32 v89, v88, v90
    v_rcp_f32 v88, v89
    v_mfma_f32_16x16x32_bf16 v[136:139], v[2:5], v[28:31], v[136:139]
    v_mul_f32 v128, v80, v128
    v_mul_f32 v129, v80, v129
    v_mfma_f32_16x16x32_bf16 v[140:143], v[4:7], v[28:31], v[140:143]
    v_mul_f32 v130, v80, v130
    v_mul_f32 v131, v80, v131
    v_mul_f32 v132, v80, v132
    v_mfma_f32_16x16x32_bf16 v[136:139], v[2:5], v[36:39], v[136:139]
    v_mul_f32 v133, v80, v133
    v_mul_f32 v134, v80, v134
    v_mfma_f32_16x16x32_bf16 v[140:143], v[4:7], v[36:39], v[140:143]
    v_mul_f32 v135, v80, v135
    v_cvt_pk_bf16_f32 v128, v128, v129
    s_waitcnt lgkmcnt(0)
    v_mfma_f32_16x16x32_bf16 v[192:195], v[2:5], v[40:43], v[192:195]
    v_cvt_pk_bf16_f32 v129, v130, v131
    v_cvt_pk_bf16_f32 v130, v132, v133
    v_mfma_f32_16x16x32_bf16 v[196:199], v[4:7], v[40:43], v[196:199]
    v_cvt_pk_bf16_f32 v131, v134, v135
    buffer_store_dwordx4 v[128:131], v13, s[64:67], s4 offen offset:0 sc1
    v_mfma_f32_16x16x32_bf16 v[192:195], v[2:5], v[48:51], v[192:195]
    v_mul_f32 v136, v84, v136
    v_mul_f32 v137, v84, v137
    v_mfma_f32_16x16x32_bf16 v[196:199], v[4:7], v[48:51], v[196:199]
    v_mul_f32 v138, v84, v138
    v_mul_f32 v139, v84, v139
    v_mul_f32 v140, v84, v140
    v_mfma_f32_16x16x32_bf16 v[192:195], v[2:5], v[56:59], v[192:195]
    v_mul_f32 v141, v84, v141
    v_mul_f32 v142, v84, v142
    v_mfma_f32_16x16x32_bf16 v[196:199], v[4:7], v[56:59], v[196:199]
    v_mul_f32 v143, v84, v143
    v_cvt_pk_bf16_f32 v136, v136, v137
    v_mfma_f32_16x16x32_bf16 v[200:203], v[2:5], v[44:47], v[200:203]
    v_cvt_pk_bf16_f32 v137, v138, v139
    v_cvt_pk_bf16_f32 v138, v140, v141
    v_cvt_pk_bf16_f32 v139, v142, v143
    buffer_store_dwordx4 v[136:139], v13, s[64:67], s4 offen offset:1024 sc1
    v_mfma_f32_16x16x32_bf16 v[204:207], v[4:7], v[44:47], v[204:207]
    v_add_f32 v92, v92, v93
    v_add_f32 v94, v94, v95
    v_add_f32 v93, v92, v94
    v_rcp_f32 v92, v93
    v_mfma_f32_16x16x32_bf16 v[200:203], v[2:5], v[52:55], v[200:203]
    v_mul_f32 v192, v88, v192
    v_mul_f32 v193, v88, v193
    v_mfma_f32_16x16x32_bf16 v[204:207], v[4:7], v[52:55], v[204:207]
    v_mul_f32 v194, v88, v194
    v_mfma_f32_16x16x32_bf16 v[200:203], v[2:5], v[60:63], v[200:203]
    v_mul_f32 v195, v88, v195
    v_mul_f32 v196, v88, v196
    v_mfma_f32_16x16x32_bf16 v[204:207], v[4:7], v[60:63], v[204:207]
    v_mul_f32 v197, v88, v197
    v_mul_f32 v198, v88, v198
    v_mul_f32 v199, v88, v199
    v_cvt_pk_bf16_f32 v192, v192, v193
    v_cvt_pk_bf16_f32 v193, v194, v195
    v_cvt_pk_bf16_f32 v194, v196, v197
    v_cvt_pk_bf16_f32 v195, v198, v199
    buffer_store_dwordx4 v[192:195], v13, s[64:67], s5 offen offset:0 sc1
    v_add_f32 v81, v81, v85
    v_add_f32 v89, v89, v93
    v_pk_mul_f32 v[200:201], v[200:201], v[92:93] op_sel_hi:[1,0]
    v_pk_mul_f32 v[202:203], v[202:203], v[92:93] op_sel_hi:[1,0]
    v_pk_mul_f32 v[204:205], v[204:205], v[92:93] op_sel_hi:[1,0]
    v_pk_mul_f32 v[206:207], v[206:207], v[92:93] op_sel_hi:[1,0]
    v_cvt_pk_bf16_f32 v200, v200, v201
    v_cvt_pk_bf16_f32 v201, v202, v203
    v_cvt_pk_bf16_f32 v202, v204, v205
    v_cvt_pk_bf16_f32 v203, v206, v207
    buffer_store_dwordx4 v[200:203], v13, s[64:67], s5 offen offset:1024 sc1
    v_add_f32 v81, v81, v89
    v_cmp_nlt_f32 vcc, v81, s53
    s_cmp_eq_u32 s76, 0
    s_cselect_b64 s[6:7], vcc, 0
    s_cmp_lg_u64 s[6:7], 0
    s_cbranch_scc1 L_fallback
    v_add_u32 v116, s88, v8
    v_add_u32 v117, s88, v9
    v_add_u32 v118, s88, v10
    v_add_u32 v119, s88, v11
    v_and_b32 v14, 1, v0
    v_sub_u32 v14, 0, v14
    s_mov_b32 s93, 0x40000
L_tag:
    s_cmp_lg_u32 s73, 0
    s_cbranch_scc1 L_tagok
    buffer_load_dword v98, v99, s[68:71], s72 offen sc1
    s_waitcnt vmcnt(0)
    v_readfirstlane_b32 s73, v98
    s_sub_u32 s93, s93, 1
    s_cbranch_scc0 L_tag
L_tagok:
    s_waitcnt vmcnt(4)
    ds_read_b64_tr_b16 a[0:1], v8 offset:0
    ds_read_b64_tr_b16 a[2:3], v8 offset:2048
    ds_read_b64_tr_b16 a[4:5], v9 offset:0
    ds_read_b64_tr_b16 a[6:7], v9 offset:2048
    ds_read_b64_tr_b16 a[8:9], v10 offset:0
    ds_read_b64_tr_b16 a[10:11], v10 offset:2048
    ds_read_b64_tr_b16 a[12:13], v11 offset:0
    ds_read_b64_tr_b16 a[14:15], v11 offset:2048
    ds_read_b64_tr_b16 a[16:17], v8 offset:4096
    ds_read_b64_tr_b16 a[18:19], v8 offset:6144
    ds_read_b64_tr_b16 a[20:21], v9 offset:4096
    ds_read_b64_tr_b16 a[22:23], v9 offset:6144
    ds_read_b64_tr_b16 a[24:25], v10 offset:4096
    ds_read_b64_tr_b16 a[26:27], v10 offset:6144
    ds_read_b64_tr_b16 a[28:29], v11 offset:4096
    ds_read_b64_tr_b16 a[30:31], v11 offset:6144
    v_xor_b32 v14, s73, v14
    v_and_b32 v124, 15, v0
    v_lshlrev_b32 v124, 2, v124
    v_mov_b32 v80, 0xff
    s_lshr_b32 s81, s73, 8
    s_lshr_b32 s82, s73, 16
    s_lshr_b32 s83, s73, 24
    v_add_u32 v81, s17, v13
    v_lshlrev_b32 v82, 8, v124
    v_lshrrev_b32 v83, 4, v0
    v_lshl_add_u32 v82, v83, 3, v82
    v_mov_b32 v84, 0x0c0c0400
    v_mov_b32 v85, 0x05040100
    v_add_u32 v86, 1, v0
    v_lshlrev_b32 v86, 2, v86
    v_xor_b32 v86, s74, v86
    v_cmp_eq_u32 vcc, 0, v0
    v_mov_b32 v87, s73
    v_add_u32 v88, 16, v86
    v_cndmask_b32 v86, v86, v88, vcc
    s_add_u32 s51, s80, 0
    s_and_b32 s51, s51, 7
    s_lshl_b32 s20, s51, 11
    s_add_u32 s51, s80, 1
    s_and_b32 s51, s51, 7
    s_lshl_b32 s21, s51, 11
    s_add_u32 s51, s80, 2
    s_and_b32 s51, s51, 7
    s_lshl_b32 s22, s51, 11
    s_add_u32 s51, s80, 3
    s_and_b32 s51, s51, 7
    s_lshl_b32 s23, s51, 11
    s_add_u32 s51, s80, 4
    s_and_b32 s51, s51, 7
    s_lshl_b32 s24, s51, 11
    s_add_u32 s51, s80, 5
    s_and_b32 s51, s51, 7
    s_lshl_b32 s25, s51, 11
    s_add_u32 s51, s80, 6
    s_and_b32 s51, s51, 7
    s_lshl_b32 s26, s51, 11
    s_add_u32 s51, s80, 7
    s_and_b32 s51, s51, 7
    s_lshl_b32 s27, s51, 11
    v_add_u32 v104, s16, v13
    v_xor_b32 v105, 0x400, v104
    v_xor_b32 v106, 0x40000, v104
    v_xor_b32 v107, 0x40400, v104
    v_mov_b32 v125, 0
    s_waitcnt vmcnt(0)
    s_mov_b64 exec, 3
    buffer_atomic_swap v14, v124, s[64:67], s77 offen sc1
    s_mov_b64 exec, 0xffff
    buffer_atomic_or v125, v124, s[64:67], s55 offen sc0 sc1
    s_mov_b64 exec, -1
    s_waitcnt lgkmcnt(0)
    s_mov_b32 m0, s87
    s_nop 0
    buffer_load_dwordx4 v112, s[36:39], s84 offen offset:0 lds
    buffer_load_dwordx4 v113, s[36:39], s84 offen offset:1024 lds
    buffer_load_dwordx4 v114, s[36:39], s84 offen offset:2048 lds
    buffer_load_dwordx4 v115, s[36:39], s84 offen offset:3072 lds
    s_add_u32 s84, s84, 0x8000
    s_and_b32 s84, s84, 0x3ffff
    s_add_u32 m0, s49, 28672
    s_nop 0
    buffer_load_dwordx4 v112, s[36:39], s84 offen offset:0 lds
    buffer_load_dwordx4 v113, s[36:39], s84 offen offset:1024 lds
    buffer_load_dwordx4 v114, s[36:39], s84 offen offset:2048 lds
    buffer_load_dwordx4 v115, s[36:39], s84 offen offset:3072 lds
    s_add_u32 s84, s84, 0x8000
    s_and_b32 s84, s84, 0x3ffff
    s_add_u32 m0, s49, 0
    s_nop 0
    buffer_load_dwordx4 v112, s[36:39], s84 offen offset:0 lds
    buffer_load_dwordx4 v113, s[36:39], s84 offen offset:1024 lds
    buffer_load_dwordx4 v114, s[36:39], s84 offen offset:2048 lds
    buffer_load_dwordx4 v115, s[36:39], s84 offen offset:3072 lds
    s_add_u32 s84, s84, 0x8000
    s_and_b32 s84, s84, 0x3ffff
    s_add_u32 m0, s49, 4096
    s_nop 0
    buffer_load_dwordx4 v112, s[36:39], s84 offen offset:0 lds
    buffer_load_dwordx4 v113, s[36:39], s84 offen offset:1024 lds
    buffer_load_dwordx4 v114, s[36:39], s84 offen offset:2048 lds
    buffer_load_dwordx4 v115, s[36:39], s84 offen offset:3072 lds
    s_add_u32 s84, s84, 0x8000
    s_and_b32 s84, s84, 0x3ffff
    ds_read_b64_tr_b16 a[32:33], v8 offset:8192
    ds_read_b64_tr_b16 a[34:35], v8 offset:10240
    ds_read_b64_tr_b16 a[36:37], v9 offset:8192
    ds_read_b64_tr_b16 a[38:39], v9 offset:10240
    ds_read_b64_tr_b16 a[40:41], v10 offset:8192
    ds_read_b64_tr_b16 a[42:43], v10 offset:10240
    ds_read_b64_tr_b16 a[44:45], v11 offset:8192
    ds_read_b64_tr_b16 a[46:47], v11 offset:10240
    ds_read_b64_tr_b16 a[48:49], v8 offset:12288
    ds_read_b64_tr_b16 a[50:51], v8 offset:14336
    ds_read_b64_tr_b16 a[52:53], v9 offset:12288
    ds_read_b64_tr_b16 a[54:55], v9 offset:14336
    ds_read_b64_tr_b16 a[56:57], v10 offset:12288
    ds_read_b64_tr_b16 a[58:59], v10 offset:14336
    ds_read_b64_tr_b16 a[60:61], v11 offset:12288
    ds_read_b64_tr_b16 a[62:63], v11 offset:14336
    s_mov_b32 s93, 0x40000
    s_waitcnt vmcnt(16)
    s_mov_b64 exec, 0xffff
L_poll:
    v_cmp_ne_u32 vcc, v14, v125
    s_cbranch_vccz L_pollend
    v_mov_b32 v125, 0
    buffer_atomic_or v125, v124, s[64:67], s55 offen sc0 sc1
    s_sub_u32 s93, s93, 1
    s_waitcnt vmcnt(0)
    s_cbranch_scc0 L_poll
L_pollend:
    s_mov_b64 exec, -1
    buffer_load_dwordx4 v[128:131], v107, s[8:11], s20 offen sc1
    buffer_load_dwordx4 v[132:135], v106, s[8:11], s20 offen sc1
    buffer_load_dwordx4 v[136:139], v107, s[8:11], s21 offen sc1
    buffer_load_dwordx4 v[140:143], v106, s[8:11], s21 offen sc1
    buffer_load_dwordx4 v[144:147], v107, s[8:11], s22 offen sc1
    buffer_load_dwordx4 v[148:151], v106, s[8:11], s22 offen sc1
    buffer_load_dwordx4 v[152:155], v107, s[8:11], s23 offen sc1
    buffer_load_dwordx4 v[156:159], v106, s[8:11], s23 offen sc1
    buffer_load_dwordx4 v[160:163], v107, s[8:11], s24 offen sc1
    buffer_load_dwordx4 v[164:167], v106, s[8:11], s24 offen sc1
    s_waitcnt vmcnt(9) lgkmcnt(0)
    v_mfma_f32_16x16x32_bf16 v[76:79], a[12:15], v[128:131], 0
    buffer_load_dwordx4 v[168:171], v107, s[8:11], s25 offen sc1
    ds_read_b64_tr_b16 a[64:65], v116 offset:0
    v_mfma_f32_16x16x32_bf16 v[72:75], a[8:11], v[128:131], 0
    ds_read_b64_tr_b16 a[66:67], v116 offset:2048
    ds_read_b64_tr_b16 a[68:69], v117 offset:0
    v_mfma_f32_16x16x32_bf16 v[68:71], a[4:7], v[128:131], 0
    ds_read_b64_tr_b16 a[70:71], v117 offset:2048
    ds_read_b64_tr_b16 a[72:73], v118 offset:0
    v_mfma_f32_16x16x32_bf16 v[64:67], a[0:3], v[128:131], 0
    s_waitcnt vmcnt(9)
    v_mfma_f32_16x16x32_bf16 v[60:63], a[12:15], v[132:135], 0
    buffer_load_dwordx4 v[172:175], v106, s[8:11], s25 offen sc1
    ds_read_b64_tr_b16 a[74:75], v118 offset:2048
    v_mfma_f32_16x16x32_bf16 v[56:59], a[8:11], v[132:135], 0
    ds_read_b64_tr_b16 a[76:77], v119 offset:0
    ds_read_b64_tr_b16 a[78:79], v119 offset:2048
    v_mfma_f32_16x16x32_bf16 v[52:55], a[4:7], v[132:135], 0
    ds_read_b64_tr_b16 a[80:81], v8 offset:28672
    ds_read_b64_tr_b16 a[82:83], v8 offset:30720
    v_mfma_f32_16x16x32_bf16 v[48:51], a[0:3], v[132:135], 0
    s_waitcnt vmcnt(9)
    v_mfma_f32_16x16x32_bf16 v[76:79], a[28:31], v[136:139], v[76:79]
    buffer_load_dwordx4 v[176:179], v107, s[8:11], s26 offen sc1
    ds_read_b64_tr_b16 a[84:85], v9 offset:28672
    v_mfma_f32_16x16x32_bf16 v[72:75], a[24:27], v[136:139], v[72:75]
    ds_read_b64_tr_b16 a[86:87], v9 offset:30720
    ds_read_b64_tr_b16 a[88:89], v10 offset:28672
    v_mfma_f32_16x16x32_bf16 v[68:71], a[20:23], v[136:139], v[68:71]
    ds_read_b64_tr_b16 a[90:91], v10 offset:30720
    ds_read_b64_tr_b16 a[92:93], v11 offset:28672
    v_mfma_f32_16x16x32_bf16 v[64:67], a[16:19], v[136:139], v[64:67]
    s_waitcnt vmcnt(9)
    v_mfma_f32_16x16x32_bf16 v[60:63], a[28:31], v[140:143], v[60:63]
    buffer_load_dwordx4 v[180:183], v106, s[8:11], s26 offen sc1
    ds_read_b64_tr_b16 a[94:95], v11 offset:30720
    v_mfma_f32_16x16x32_bf16 v[56:59], a[24:27], v[140:143], v[56:59]
    ds_read_b64_tr_b16 a[96:97], v8 offset:0
    ds_read_b64_tr_b16 a[98:99], v8 offset:2048
    v_mfma_f32_16x16x32_bf16 v[52:55], a[20:23], v[140:143], v[52:55]
    ds_read_b64_tr_b16 a[100:101], v9 offset:0
    ds_read_b64_tr_b16 a[102:103], v9 offset:2048
    v_mfma_f32_16x16x32_bf16 v[48:51], a[16:19], v[140:143], v[48:51]
    s_waitcnt vmcnt(9)
    v_mfma_f32_16x16x32_bf16 v[76:79], a[44:47], v[144:147], v[76:79]
    buffer_load_dwordx4 v[184:187], v107, s[8:11], s27 offen sc1
    ds_read_b64_tr_b16 a[104:105], v10 offset:0
    v_mfma_f32_16x16x32_bf16 v[72:75], a[40:43], v[144:147], v[72:75]
    ds_read_b64_tr_b16 a[106:107], v10 offset:2048
    ds_read_b64_tr_b16 a[108:109], v11 offset:0
    v_mfma_f32_16x16x32_bf16 v[68:71], a[36:39], v[144:147], v[68:71]
    ds_read_b64_tr_b16 a[110:111], v11 offset:2048
    ds_read_b64_tr_b16 a[112:113], v8 offset:4096
    v_mfma_f32_16x16x32_bf16 v[64:67], a[32:35], v[144:147], v[64:67]
    s_waitcnt vmcnt(9)
    v_mfma_f32_16x16x32_bf16 v[60:63], a[44:47], v[148:151], v[60:63]
    buffer_load_dwordx4 v[188:191], v106, s[8:11], s27 offen sc1
    ds_read_b64_tr_b16 a[114:115], v8 offset:6144
    v_mfma_f32_16x16x32_bf16 v[56:59], a[40:43], v[148:151], v[56:59]
    ds_read_b64_tr_b16 a[116:117], v9 offset:4096
    ds_read_b64_tr_b16 a[118:119], v9 offset:6144
    v_mfma_f32_16x16x32_bf16 v[52:55], a[36:39], v[148:151], v[52:55]
    ds_read_b64_tr_b16 a[120:121], v10 offset:4096
    ds_read_b64_tr_b16 a[122:123], v10 offset:6144
    v_mfma_f32_16x16x32_bf16 v[48:51], a[32:35], v[148:151], v[48:51]
    s_waitcnt vmcnt(9)
    v_mfma_f32_16x16x32_bf16 v[76:79], a[60:63], v[152:155], v[76:79]
    buffer_load_dwordx4 v[192:195], v105, s[8:11], s20 offen sc1
    ds_read_b64_tr_b16 a[124:125], v11 offset:4096
    v_mfma_f32_16x16x32_bf16 v[72:75], a[56:59], v[152:155], v[72:75]
    ds_read_b64_tr_b16 a[126:127], v11 offset:6144
    v_mfma_f32_16x16x32_bf16 v[68:71], a[52:55], v[152:155], v[68:71]
    v_mfma_f32_16x16x32_bf16 v[64:67], a[48:51], v[152:155], v[64:67]
    s_waitcnt vmcnt(9)
    v_mfma_f32_16x16x32_bf16 v[60:63], a[60:63], v[156:159], v[60:63]
    buffer_load_dwordx4 v[196:199], v105, s[8:11], s21 offen sc1
    v_mfma_f32_16x16x32_bf16 v[56:59], a[56:59], v[156:159], v[56:59]
    v_mfma_f32_16x16x32_bf16 v[52:55], a[52:55], v[156:159], v[52:55]
    s_waitcnt lgkmcnt(0)
    v_mfma_f32_16x16x32_bf16 v[48:51], a[48:51], v[156:159], v[48:51]
    s_waitcnt vmcnt(9)
    v_mfma_f32_16x16x32_bf16 v[76:79], a[76:79], v[160:163], v[76:79]
    buffer_load_dwordx4 v[200:203], v105, s[8:11], s22 offen sc1
    v_mfma_f32_16x16x32_bf16 v[72:75], a[72:75], v[160:163], v[72:75]
    v_mfma_f32_16x16x32_bf16 v[68:71], a[68:71], v[160:163], v[68:71]
    v_mfma_f32_16x16x32_bf16 v[64:67], a[64:67], v[160:163], v[64:67]
    s_waitcnt vmcnt(9)
    v_mfma_f32_16x16x32_bf16 v[60:63], a[76:79], v[164:167], v[60:63]
    buffer_load_dwordx4 v[204:207], v105, s[8:11], s23 offen sc1
    v_mfma_f32_16x16x32_bf16 v[56:59], a[72:75], v[164:167], v[56:59]
    v_mfma_f32_16x16x32_bf16 v[52:55], a[68:71], v[164:167], v[52:55]
    v_mfma_f32_16x16x32_bf16 v[48:51], a[64:67], v[164:167], v[48:51]
    s_waitcnt vmcnt(9)
    v_mfma_f32_16x16x32_bf16 v[76:79], a[92:95], v[168:171], v[76:79]
    buffer_load_dwordx4 v[208:211], v105, s[8:11], s24 offen sc1
    v_mfma_f32_16x16x32_bf16 v[72:75], a[88:91], v[168:171], v[72:75]
    v_mfma_f32_16x16x32_bf16 v[68:71], a[84:87], v[168:171], v[68:71]
    v_mfma_f32_16x16x32_bf16 v[64:67], a[80:83], v[168:171], v[64:67]
    s_waitcnt vmcnt(9)
    v_mfma_f32_16x16x32_bf16 v[60:63], a[92:95], v[172:175], v[60:63]
    buffer_load_dwordx4 v[212:215], v105, s[8:11], s25 offen sc1
    v_mfma_f32_16x16x32_bf16 v[56:59], a[88:91], v[172:175], v[56:59]
    v_mfma_f32_16x16x32_bf16 v[52:55], a[84:87], v[172:175], v[52:55]
    v_mfma_f32_16x16x32_bf16 v[48:51], a[80:83], v[172:175], v[48:51]
    s_waitcnt vmcnt(9)
    v_mfma_f32_16x16x32_bf16 v[76:79], a[108:111], v[176:179], v[76:79]
    buffer_load_dwordx4 v[216:219], v105, s[8:11], s26 offen sc1
    v_mfma_f32_16x16x32_bf16 v[72:75], a[104:107], v[176:179], v[72:75]
    v_mfma_f32_16x16x32_bf16 v[68:71], a[100:103], v[176:179], v[68:71]
    v_mfma_f32_16x16x32_bf16 v[64:67], a[96:99], v[176:179], v[64:67]
    s_waitcnt vmcnt(9)
    v_mfma_f32_16x16x32_bf16 v[60:63], a[108:111], v[180:183], v[60:63]
    buffer_load_dwordx4 v[220:223], v105, s[8:11], s27 offen sc1
    v_mfma_f32_16x16x32_bf16 v[56:59], a[104:107], v[180:183], v[56:59]
    v_mfma_f32_16x16x32_bf16 v[52:55], a[100:103], v[180:183], v[52:55]
    v_mfma_f32_16x16x32_bf16 v[48:51], a[96:99], v[180:183], v[48:51]
    s_waitcnt vmcnt(9)
    v_mfma_f32_16x16x32_bf16 v[76:79], a[124:127], v[184:187], v[76:79]
    buffer_load_dwordx4 v[224:227], v104, s[8:11], s20 offen sc1
    v_mfma_f32_16x16x32_bf16 v[72:75], a[120:123], v[184:187], v[72:75]
    v_mfma_f32_16x16x32_bf16 v[68:71], a[116:119], v[184:187], v[68:71]
    v_mfma_f32_16x16x32_bf16 v[64:67], a[112:115], v[184:187], v[64:67]
    s_waitcnt vmcnt(9)
    v_mfma_f32_16x16x32_bf16 v[60:63], a[124:127], v[188:191], v[60:63]
    buffer_load_dwordx4 v[228:231], v104, s[8:11], s21 offen sc1
    v_mfma_f32_16x16x32_bf16 v[56:59], a[120:123], v[188:191], v[56:59]
    v_mfma_f32_16x16x32_bf16 v[52:55], a[116:119], v[188:191], v[52:55]
    v_mfma_f32_16x16x32_bf16 v[48:51], a[112:115], v[188:191], v[48:51]
    s_waitcnt vmcnt(9)
    v_mfma_f32_16x16x32_bf16 v[44:47], a[12:15], v[192:195], 0
    buffer_load_dwordx4 v[232:235], v104, s[8:11], s22 offen sc1
    v_mfma_f32_16x16x32_bf16 v[40:43], a[8:11], v[192:195], 0
    v_mfma_f32_16x16x32_bf16 v[36:39], a[4:7], v[192:195], 0
    ds_write_b128 v12, v[68:71] offset:9216
    ds_write_b128 v12, v[72:75] offset:10240
    v_mfma_f32_16x16x32_bf16 v[32:35], a[0:3], v[192:195], 0
    s_waitcnt vmcnt(9)
    v_mfma_f32_16x16x32_bf16 v[44:47], a[28:31], v[196:199], v[44:47]
    buffer_load_dwordx4 v[236:239], v104, s[8:11], s23 offen sc1
    ds_write_b128 v12, v[76:79] offset:11264
    v_mfma_f32_16x16x32_bf16 v[40:43], a[24:27], v[196:199], v[40:43]
    v_mfma_f32_16x16x32_bf16 v[36:39], a[20:23], v[196:199], v[36:39]
    ds_write_b128 v12, v[52:55] offset:6144
    v_mfma_f32_16x16x32_bf16 v[32:35], a[16:19], v[196:199], v[32:35]
    s_waitcnt vmcnt(9)
    v_mfma_f32_16x16x32_bf16 v[44:47], a[44:47], v[200:203], v[44:47]
    buffer_load_dwordx4 v[240:243], v104, s[8:11], s24 offen sc1
    ds_write_b128 v12, v[56:59] offset:7168
    v_mfma_f32_16x16x32_bf16 v[40:43], a[40:43], v[200:203], v[40:43]
    v_mfma_f32_16x16x32_bf16 v[36:39], a[36:39], v[200:203], v[36:39]
    ds_write_b128 v12, v[60:63] offset:8192
    v_mfma_f32_16x16x32_bf16 v[32:35], a[32:35], v[200:203], v[32:35]
    s_waitcnt vmcnt(9)
    v_mfma_f32_16x16x32_bf16 v[44:47], a[60:63], v[204:207], v[44:47]
    buffer_load_dwordx4 v[244:247], v104, s[8:11], s25 offen sc1
    v_mfma_f32_16x16x32_bf16 v[40:43], a[56:59], v[204:207], v[40:43]
    v_mfma_f32_16x16x32_bf16 v[36:39], a[52:55], v[204:207], v[36:39]
    s_waitcnt lgkmcnt(0)
    s_barrier
    ds_read_b128 v[68:71], v101 offset:9216
    ds_read_b128 v[72:75], v102 offset:10240
    v_mfma_f32_16x16x32_bf16 v[32:35], a[48:51], v[204:207], v[32:35]
    ds_read_b128 v[76:79], v103 offset:11264
    ds_read_b128 v[52:55], v101 offset:6144
    ds_read_b128 v[56:59], v102 offset:7168
    ds_read_b128 v[60:63], v103 offset:8192
    s_waitcnt vmcnt(9)
    v_mfma_f32_16x16x32_bf16 v[44:47], a[76:79], v[208:211], v[44:47]
    buffer_load_dwordx4 v[248:251], v104, s[8:11], s26 offen sc1
    v_mfma_f32_16x16x32_bf16 v[40:43], a[72:75], v[208:211], v[40:43]
    v_mfma_f32_16x16x32_bf16 v[36:39], a[68:71], v[208:211], v[36:39]
    v_mfma_f32_16x16x32_bf16 v[32:35], a[64:67], v[208:211], v[32:35]
    s_waitcnt vmcnt(9)
    v_mfma_f32_16x16x32_bf16 v[44:47], a[92:95], v[212:215], v[44:47]
    buffer_load_dwordx4 v[252:255], v104, s[8:11], s27 offen sc1
    s_waitcnt lgkmcnt(0)
    v_add_f32 v64, v64, v68
    v_mfma_f32_16x16x32_bf16 v[40:43], a[88:91], v[212:215], v[40:43]
    v_add_f32 v72, v72, v76
    v_add_f32 v65, v65, v69
    v_add_f32 v73, v73, v77
    v_mfma_f32_16x16x32_bf16 v[36:39], a[84:87], v[212:215], v[36:39]
    v_add_f32 v66, v66, v70
    v_add_f32 v74, v74, v78
    v_mfma_f32_16x16x32_bf16 v[32:35], a[80:83], v[212:215], v[32:35]
    v_add_f32 v67, v67, v71
    v_add_f32 v75, v75, v79
    v_add_f32 v64, v64, v72
    s_waitcnt vmcnt(9)
    v_mfma_f32_16x16x32_bf16 v[44:47], a[108:111], v[216:219], v[44:47]
    v_add_f32 v65, v65, v73
    v_add_f32 v66, v66, v74
    v_mfma_f32_16x16x32_bf16 v[40:43], a[104:107], v[216:219], v[40:43]
    v_add_f32 v67, v67, v75
    v_bfi_b32 v64, v80, s73, v64
    v_bfi_b32 v65, v80, s81, v65
    v_mfma_f32_16x16x32_bf16 v[36:39], a[100:103], v[216:219], v[36:39]
    v_bfi_b32 v66, v80, s82, v66
    v_bfi_b32 v67, v80, s83, v67
    v_mfma_f32_16x16x32_bf16 v[32:35], a[96:99], v[216:219], v[32:35]
    buffer_store_dwordx4 v[64:67], v81, s[64:67], s96 offen sc1
    v_add_f32 v48, v48, v52
    v_add_f32 v56, v56, v60
    s_waitcnt vmcnt(9)
    v_mfma_f32_16x16x32_bf16 v[44:47], a[124:127], v[220:223], v[44:47]
    v_add_f32 v49, v49, v53
    v_add_f32 v57, v57, v61
    v_mfma_f32_16x16x32_bf16 v[40:43], a[120:123], v[220:223], v[40:43]
    v_add_f32 v50, v50, v54
    v_add_f32 v58, v58, v62
    v_add_f32 v51, v51, v55
    v_mfma_f32_16x16x32_bf16 v[36:39], a[116:119], v[220:223], v[36:39]
    v_add_f32 v59, v59, v63
    v_add_f32 v48, v48, v56
    v_mfma_f32_16x16x32_bf16 v[32:35], a[112:115], v[220:223], v[32:35]
    v_add_f32 v49, v49, v57
    v_add_f32 v50, v50, v58
    v_add_f32 v51, v51, v59
    s_waitcnt vmcnt(8)
    v_mfma_f32_16x16x32_bf16 v[28:31], a[12:15], v[224:227], 0
    v_bfi_b32 v48, v80, s73, v48
    v_bfi_b32 v49, v80, s81, v49
    v_mfma_f32_16x16x32_bf16 v[24:27], a[8:11], v[224:227], 0
    v_bfi_b32 v50, v80, s82, v50
    v_bfi_b32 v51, v80, s83, v51
    buffer_store_dwordx4 v[48:51], v81, s[64:67], s95 offen sc1
    v_mfma_f32_16x16x32_bf16 v[20:23], a[4:7], v[224:227], 0
    ds_write_b128 v12, v[36:39] offset:3072
    ds_write_b128 v12, v[40:43] offset:4096
    v_mfma_f32_16x16x32_bf16 v[16:19], a[0:3], v[224:227], 0
    s_mov_b64 exec, 1
    buffer_atomic_swap v87, v99, s[64:67], s75 offen offset:0 sc1
    s_mov_b64 exec, -1
    s_waitcnt vmcnt(9)
    v_mfma_f32_16x16x32_bf16 v[28:31], a[28:31], v[228:231], v[28:31]
    ds_write_b128 v12, v[44:47] offset:5120
    v_mfma_f32_16x16x32_bf16 v[24:27], a[24:27], v[228:231], v[24:27]
    s_mov_b64 exec, 1
    buffer_atomic_swap v87, v99, s[64:67], s75 offen offset:16 sc1
    s_mov_b64 exec, -1
    v_mfma_f32_16x16x32_bf16 v[20:23], a[20:23], v[228:231], v[20:23]
    v_mfma_f32_16x16x32_bf16 v[16:19], a[16:19], v[228:231], v[16:19]
    s_waitcnt vmcnt(9)
    v_mfma_f32_16x16x32_bf16 v[28:31], a[44:47], v[232:235], v[28:31]
    s_waitcnt lgkmcnt(0)
    s_barrier
    v_mfma_f32_16x16x32_bf16 v[24:27], a[40:43], v[232:235], v[24:27]
    ds_read_b128 v[36:39], v101 offset:3072
    ds_read_b128 v[40:43], v102 offset:4096
    ds_read_b128 v[44:47], v103 offset:5120
    v_mfma_f32_16x16x32_bf16 v[20:23], a[36:39], v[232:235], v[20:23]
    v_mfma_f32_16x16x32_bf16 v[16:19], a[32:35], v[232:235], v[16:19]
    s_waitcnt vmcnt(8)
    v_mfma_f32_16x16x32_bf16 v[28:31], a[60:63], v[236:239], v[28:31]
    v_mfma_f32_16x16x32_bf16 v[24:27], a[56:59], v[236:239], v[24:27]
    v_mfma_f32_16x16x32_bf16 v[20:23], a[52:55], v[236:239], v[20:23]
    s_waitcnt lgkmcnt(0)
    v_add_f32 v32, v32, v36
    v_mfma_f32_16x16x32_bf16 v[16:19], a[48:51], v[236:239], v[16:19]
    v_add_f32 v40, v40, v44
    v_add_f32 v33, v33, v37
    s_waitcnt vmcnt(7)
    v_mfma_f32_16x16x32_bf16 v[28:31], a[76:79], v[240:243], v[28:31]
    v_add_f32 v41, v41, v45
    v_add_f32 v34, v34, v38
    v_mfma_f32_16x16x32_bf16 v[24:27], a[72:75], v[240:243], v[24:27]
    v_add_f32 v42, v42, v46
    v_add_f32 v35, v35, v39
    v_mfma_f32_16x16x32_bf16 v[20:23], a[68:71], v[240:243], v[20:23]
    v_add_f32 v43, v43, v47
    v_add_f32 v32, v32, v40
    v_mfma_f32_16x16x32_bf16 v[16:19], a[64:67], v[240:243], v[16:19]
    v_add_f32 v33, v33, v41
    s_waitcnt vmcnt(6)
    v_mfma_f32_16x16x32_bf16 v[28:31], a[92:95], v[244:247], v[28:31]
    v_add_f32 v34, v34, v42
    v_add_f32 v35, v35, v43
    v_mfma_f32_16x16x32_bf16 v[24:27], a[88:91], v[244:247], v[24:27]
    v_bfi_b32 v32, v80, s73, v32
    v_bfi_b32 v33, v80, s81, v33
    v_mfma_f32_16x16x32_bf16 v[20:23], a[84:87], v[244:247], v[20:23]
    v_bfi_b32 v34, v80, s82, v34
    v_bfi_b32 v35, v80, s83, v35
    v_mfma_f32_16x16x32_bf16 v[16:19], a[80:83], v[244:247], v[16:19]
    buffer_store_dwordx4 v[32:35], v81, s[64:67], s94 offen sc1
    s_waitcnt vmcnt(6)
    v_mfma_f32_16x16x32_bf16 v[28:31], a[108:111], v[248:251], v[28:31]
    v_mfma_f32_16x16x32_bf16 v[24:27], a[104:107], v[248:251], v[24:27]
    v_mfma_f32_16x16x32_bf16 v[20:23], a[100:103], v[248:251], v[20:23]
    v_mov_b32 v88, 0
    v_mfma_f32_16x16x32_bf16 v[16:19], a[96:99], v[248:251], v[16:19]
    s_mov_b64 exec, 7
    buffer_atomic_or v88, v86, s[64:67], s86 offen sc0 sc1
    s_mov_b64 exec, -1
    s_waitcnt vmcnt(6)
    v_mfma_f32_16x16x32_bf16 v[28:31], a[124:127], v[252:255], v[28:31]
    v_mfma_f32_16x16x32_bf16 v[24:27], a[120:123], v[252:255], v[24:27]
    v_mfma_f32_16x16x32_bf16 v[20:23], a[116:119], v[252:255], v[20:23]
    v_mfma_f32_16x16x32_bf16 v[16:19], a[112:115], v[252:255], v[16:19]
    s_nop 3
    ds_write_b128 v12, v[28:31] offset:2048
    ds_write_b128 v12, v[24:27] offset:1024
    ds_write_b128 v12, v[20:23] offset:0
    s_waitcnt lgkmcnt(0)
    s_barrier
    ds_read_b128 v[20:23], v101 offset:0
    ds_read_b128 v[24:27], v102 offset:1024
    ds_read_b128 v[28:31], v103 offset:2048
    s_waitcnt lgkmcnt(0)
    v_pk_add_f32 v[16:17], v[16:17], v[20:21]
    v_pk_add_f32 v[24:25], v[24:25], v[28:29]
    v_pk_add_f32 v[18:19], v[18:19], v[22:23]
    v_pk_add_f32 v[26:27], v[26:27], v[30:31]
    v_pk_add_f32 v[16:17], v[16:17], v[24:25]
    v_pk_add_f32 v[18:19], v[18:19], v[26:27]
    s_mov_b32 s93, 0x40000
    s_mov_b64 exec, 7
    v_mov_b32 v89, 0
L_h:
    buffer_atomic_or v89, v86, s[64:67], s86 offen sc0 sc1
    s_waitcnt vmcnt(1)
    v_cmp_ne_u32 vcc, v87, v88
    s_cbranch_vccz L_hend
    v_mov_b32 v88, 0
    buffer_atomic_or v88, v86, s[64:67], s86 offen sc0 sc1
    s_waitcnt vmcnt(1)
    v_cmp_ne_u32 vcc, v87, v89
    s_cbranch_vccz L_hend
    v_mov_b32 v89, 0
    s_sub_u32 s93, s93, 1
    s_cbranch_scc0 L_h
L_hend:
    s_mov_b64 exec, -1
    s_mov_b32 s93, 0x40000
L_x:
    buffer_load_dwordx4 v[48:51], v81, s[64:67], s97 offen sc1
    buffer_load_dwordx4 v[52:55], v81, s[64:67], s98 offen sc1
    buffer_load_dwordx4 v[56:59], v81, s[64:67], s99 offen sc1
L_xw:
    s_waitcnt vmcnt(0)
    v_perm_b32 v60, v49, v48, v84
    v_perm_b32 v61, v51, v50, v84
    v_perm_b32 v62, v53, v52, v84
    v_perm_b32 v63, v55, v54, v84
    v_perm_b32 v64, v57, v56, v84
    v_perm_b32 v65, v59, v58, v84
    v_perm_b32 v60, v61, v60, v85
    v_perm_b32 v62, v63, v62, v85
    v_perm_b32 v64, v65, v64, v85
    v_xor_b32 v60, s73, v60
    v_xor_b32 v62, s73, v62
    v_xor_b32 v64, s73, v64
    v_or3_b32 v60, v60, v62, v64
    v_cmp_ne_u32 vcc, 0, v60
    s_cbranch_vccz L_xend
    s_sub_u32 s93, s93, 1
    s_cbranch_scc0 L_x
L_xend:
    v_and_b32 v48, 0xffffff00, v48
    v_and_b32 v49, 0xffffff00, v49
    v_and_b32 v50, 0xffffff00, v50
    v_and_b32 v51, 0xffffff00, v51
    v_and_b32 v52, 0xffffff00, v52
    v_and_b32 v53, 0xffffff00, v53
    v_and_b32 v54, 0xffffff00, v54
    v_and_b32 v55, 0xffffff00, v55
    v_and_b32 v56, 0xffffff00, v56
    v_and_b32 v57, 0xffffff00, v57
    v_and_b32 v58, 0xffffff00, v58
    v_and_b32 v59, 0xffffff00, v59
    v_pk_add_f32 v[16:17], v[16:17], v[48:49]
    v_pk_add_f32 v[52:53], v[52:53], v[56:57]
    v_pk_add_f32 v[18:19], v[18:19], v[50:51]
    v_pk_add_f32 v[54:55], v[54:55], v[58:59]
    v_pk_add_f32 v[16:17], v[16:17], v[52:53]
    v_pk_add_f32 v[18:19], v[18:19], v[54:55]
    v_cvt_pk_bf16_f32 v16, v16, v17
    v_cvt_pk_bf16_f32 v17, v18, v19
    buffer_store_dwordx2 v[16:17], v82, s[12:15], s50 offen
L_end:
    s_endpgm
L_fallback:
    s_mov_b32 s76, 1
    s_waitcnt vmcnt(0) lgkmcnt(0)
    s_barrier
    v_xor_b32 v101, 64, v100
    v_xor_b32 v102, 128, v100
    v_xor_b32 v103, 192, v100
    ds_write_b128 v15, a[128:131] offset:0
    ds_write_b128 v15, a[132:135] offset:1024
    ds_write_b128 v15, a[136:139] offset:2048
    ds_write_b128 v15, a[140:143] offset:3072
    ds_write_b128 v15, a[144:147] offset:4096
    ds_write_b128 v15, a[148:151] offset:5120
    ds_write_b128 v15, a[152:155] offset:6144
    ds_write_b128 v15, a[156:159] offset:7168
    ds_write_b128 v15, a[160:163] offset:8192
    ds_write_b128 v15, a[164:167] offset:9216
    ds_write_b128 v15, a[168:171] offset:10240
    ds_write_b128 v15, a[172:175] offset:11264
    ds_write_b128 v15, a[176:179] offset:12288
    ds_write_b128 v15, a[180:183] offset:13312
    ds_write_b128 v15, a[184:187] offset:14336
    ds_write_b128 v15, a[188:191] offset:15360
    v_subrev_u32 v112, 4096, v116
    v_xor_b32 v113, 64, v112
    v_xor_b32 v114, 128, v112
    v_xor_b32 v115, 192, v112
    s_mov_b32 s54, 0
L_fb_loop:
    s_add_u32 m0, s49, 0
    s_nop 0
    buffer_load_dwordx4 v112, s[24:27], s54 offen offset:0 lds
    buffer_load_dwordx4 v113, s[24:27], s54 offen offset:1024 lds
    buffer_load_dwordx4 v114, s[24:27], s54 offen offset:2048 lds
    buffer_load_dwordx4 v115, s[24:27], s54 offen offset:3072 lds
    s_add_u32 m0, s49, 4096
    s_nop 0
    buffer_load_dwordx4 v116, s[24:27], s54 offen offset:0 lds
    buffer_load_dwordx4 v117, s[24:27], s54 offen offset:1024 lds
    buffer_load_dwordx4 v118, s[24:27], s54 offen offset:2048 lds
    buffer_load_dwordx4 v119, s[24:27], s54 offen offset:3072 lds
    s_waitcnt vmcnt(0)
    ds_read_b128 a[192:195], v100 offset:0
    ds_read_b128 a[196:199], v100 offset:4096
    ds_read_b128 a[200:203], v101 offset:0
    ds_read_b128 a[204:207], v101 offset:4096
    ds_read_b128 a[208:211], v102 offset:0
    ds_read_b128 a[212:215], v102 offset:4096
    ds_read_b128 a[216:219], v103 offset:0
    ds_read_b128 a[220:223], v103 offset:4096
    s_waitcnt lgkmcnt(0)
    v_mfma_f32_16x16x32_bf16 v[16:19], a[192:195], a[128:131], 0
    v_mfma_f32_16x16x32_bf16 v[20:23], a[196:199], a[128:131], 0
    v_mfma_f32_16x16x32_bf16 v[16:19], a[200:203], a[132:135], v[16:19]
    v_mfma_f32_16x16x32_bf16 v[20:23], a[204:207], a[132:135], v[20:23]
    v_mfma_f32_16x16x32_bf16 v[16:19], a[208:211], a[136:139], v[16:19]
    v_mfma_f32_16x16x32_bf16 v[20:23], a[212:215], a[136:139], v[20:23]
    v_mfma_f32_16x16x32_bf16 v[16:19], a[216:219], a[140:143], v[16:19]
    v_mfma_f32_16x16x32_bf16 v[20:23], a[220:223], a[140:143], v[20:23]
    v_mfma_f32_16x16x32_bf16 v[24:27], a[192:195], a[144:147], 0
    v_mfma_f32_16x16x32_bf16 v[28:31], a[196:199], a[144:147], 0
    v_mfma_f32_16x16x32_bf16 v[24:27], a[200:203], a[148:151], v[24:27]
    v_mfma_f32_16x16x32_bf16 v[28:31], a[204:207], a[148:151], v[28:31]
    v_mfma_f32_16x16x32_bf16 v[24:27], a[208:211], a[152:155], v[24:27]
    v_mfma_f32_16x16x32_bf16 v[28:31], a[212:215], a[152:155], v[28:31]
    v_mfma_f32_16x16x32_bf16 v[24:27], a[216:219], a[156:159], v[24:27]
    v_mfma_f32_16x16x32_bf16 v[28:31], a[220:223], a[156:159], v[28:31]
    v_mfma_f32_16x16x32_bf16 v[32:35], a[192:195], a[160:163], 0
    v_mfma_f32_16x16x32_bf16 v[36:39], a[196:199], a[160:163], 0
    v_mfma_f32_16x16x32_bf16 v[32:35], a[200:203], a[164:167], v[32:35]
    v_mfma_f32_16x16x32_bf16 v[36:39], a[204:207], a[164:167], v[36:39]
    v_mfma_f32_16x16x32_bf16 v[32:35], a[208:211], a[168:171], v[32:35]
    v_mfma_f32_16x16x32_bf16 v[36:39], a[212:215], a[168:171], v[36:39]
    v_mfma_f32_16x16x32_bf16 v[32:35], a[216:219], a[172:175], v[32:35]
    v_mfma_f32_16x16x32_bf16 v[36:39], a[220:223], a[172:175], v[36:39]
    v_mfma_f32_16x16x32_bf16 v[40:43], a[192:195], a[176:179], 0
    v_mfma_f32_16x16x32_bf16 v[44:47], a[196:199], a[176:179], 0
    v_mfma_f32_16x16x32_bf16 v[40:43], a[200:203], a[180:183], v[40:43]
    v_mfma_f32_16x16x32_bf16 v[44:47], a[204:207], a[180:183], v[44:47]
    v_mfma_f32_16x16x32_bf16 v[40:43], a[208:211], a[184:187], v[40:43]
    v_mfma_f32_16x16x32_bf16 v[44:47], a[212:215], a[184:187], v[44:47]
    v_mfma_f32_16x16x32_bf16 v[40:43], a[216:219], a[188:191], v[40:43]
    v_mfma_f32_16x16x32_bf16 v[44:47], a[220:223], a[188:191], v[44:47]
    s_nop 7
    v_max3_f32 v76, v76, v16, v17
    v_max3_f32 v76, v76, v18, v19
    v_max3_f32 v76, v76, v20, v21
    v_max3_f32 v76, v76, v22, v23
    v_max3_f32 v77, v77, v24, v25
    v_max3_f32 v77, v77, v26, v27
    v_max3_f32 v77, v77, v28, v29
    v_max3_f32 v77, v77, v30, v31
    v_max3_f32 v78, v78, v32, v33
    v_max3_f32 v78, v78, v34, v35
    v_max3_f32 v78, v78, v36, v37
    v_max3_f32 v78, v78, v38, v39
    v_max3_f32 v79, v79, v40, v41
    v_max3_f32 v79, v79, v42, v43
    v_max3_f32 v79, v79, v44, v45
    v_max3_f32 v79, v79, v46, v47
    s_add_u32 s54, s54, 8192
    s_cmp_lt_u32 s54, 65536
    s_cbranch_scc1 L_fb_loop
    v_permlane32_swap_b32 v76, v78
    v_permlane32_swap_b32 v77, v79
    s_nop 0
    v_max_f32 v76, v76, v78
    v_max_f32 v77, v77, v79
    s_nop 1
    v_permlane16_swap_b32 v76, v77
    s_nop 0
    v_max_f32 v76, v76, v77
    s_lshl_b32 s51, s3, 2
    s_add_u32 s51, s51, 149504
    v_add_u32 v12, s51, v13
    ds_write_b32 v12, v76
    s_waitcnt lgkmcnt(0)
    s_barrier
    ds_read_b128 v[16:19], v96 offset:2048
    ds_read_b128 v[20:23], v96 offset:2304
    ds_read_b128 v[24:27], v96 offset:2560
    ds_read_b128 v[28:31], v96 offset:2816
    s_waitcnt lgkmcnt(0)
    v_max_f32 v76, v16, v17
    v_max3_f32 v76, v18, v19, v76
    v_max_f32 v77, v20, v21
    v_max3_f32 v77, v22, v23, v77
    v_max_f32 v78, v24, v25
    v_max3_f32 v78, v26, v27, v78
    v_max_f32 v79, v28, v29
    v_max3_f32 v79, v30, v31, v79
    s_mov_b64 s[60:61], s[62:63]
    s_and_b32 s54, s60, 0x1e000
    s_lshr_b64 s[60:61], s[60:61], 4
    s_add_u32 m0, s49, 0
    s_nop 0
    buffer_load_dwordx4 v112, s[24:27], s54 offen offset:0 lds
    buffer_load_dwordx4 v113, s[24:27], s54 offen offset:1024 lds
    buffer_load_dwordx4 v114, s[24:27], s54 offen offset:2048 lds
    buffer_load_dwordx4 v115, s[24:27], s54 offen offset:3072 lds
    s_add_u32 m0, s49, 4096
    s_nop 0
    buffer_load_dwordx4 v116, s[24:27], s54 offen offset:0 lds
    buffer_load_dwordx4 v117, s[24:27], s54 offen offset:1024 lds
    buffer_load_dwordx4 v118, s[24:27], s54 offen offset:2048 lds
    buffer_load_dwordx4 v119, s[24:27], s54 offen offset:3072 lds
    s_add_u32 m0, s49, 8192
    s_nop 0
    buffer_load_dwordx4 v120, s[28:31], s54 offen offset:0 lds
    buffer_load_dwordx4 v121, s[28:31], s54 offen offset:1024 lds
    buffer_load_dwordx4 v120, s[28:31], s54 offen offset:2048 lds
    buffer_load_dwordx4 v121, s[28:31], s54 offen offset:3072 lds
    s_add_u32 m0, s49, 12288
    s_nop 0
    buffer_load_dwordx4 v122, s[28:31], s54 offen offset:0 lds
    buffer_load_dwordx4 v123, s[28:31], s54 offen offset:1024 lds
    buffer_load_dwordx4 v122, s[28:31], s54 offen offset:2048 lds
    buffer_load_dwordx4 v123, s[28:31], s54 offen offset:3072 lds
    v_mov_b32 v60, 0
    v_mov_b32 v61, 0
    v_mov_b32 v62, 0
    v_mov_b32 v63, 0
    s_nop 1
    v_mfma_f32_32x32x16_bf16 v[128:143], v[60:63], v[60:63], 0
    v_mfma_f32_32x32x16_bf16 v[144:159], v[60:63], v[60:63], 0
    v_mfma_f32_32x32x16_bf16 v[160:175], v[60:63], v[60:63], 0
    v_mfma_f32_32x32x16_bf16 v[176:191], v[60:63], v[60:63], 0
    v_mfma_f32_32x32x16_bf16 v[192:207], v[60:63], v[60:63], 0
    v_mfma_f32_32x32x16_bf16 v[208:223], v[60:63], v[60:63], 0
    v_mfma_f32_32x32x16_bf16 v[224:239], v[60:63], v[60:63], 0
    v_mfma_f32_32x32x16_bf16 v[240:255], v[60:63], v[60:63], 0
    s_waitcnt vmcnt(0)
    s_branch L_att
.section .rodata,"a"
.p2align 6
.amdhsa_kernel standalone__gqa_block_cached__near_ridge_kernel
  .amdhsa_next_free_vgpr 512
  .amdhsa_next_free_sgpr 102
  .amdhsa_accum_offset 256
  .amdhsa_group_segment_fixed_size 0
  .amdhsa_kernarg_size 64
  .amdhsa_user_sgpr_count 2
  .amdhsa_user_sgpr_kernarg_segment_ptr 1
  .amdhsa_system_sgpr_workgroup_id_x 1
.end_amdhsa_kernel
```
